```python
import torch

def _softmax(x, axis=-1):
    return torch.softmax(x, dim=axis)
def _gelu(x):
    return torch.nn.functional.gelu(x, approximate="tanh")
def _silu(x):
    return torch.nn.functional.silu(x)
def _sigmoid(x):
    return torch.sigmoid(x)
def _layernorm(x, axis=-1, eps=1e-5):
    m = x.mean(dim=axis, keepdim=True)
    v = x.var(dim=axis, keepdim=True, unbiased=False)
    return (x - m) / torch.sqrt(v + eps)
def _scatter_add(tgt, idx, src, axis=0):
    return tgt.clone().index_add_(axis, idx, src)
def _segment_sum(src, seg, n):
    out = torch.zeros((n,) + src.shape[1:], dtype=src.dtype)
    return out.index_add_(0, seg, src)
def _pad(x, pw):
    flat = tuple(v for pair in reversed(pw) for v in pair)
    return torch.nn.functional.pad(x, flat)

kernel_name = 'parallel_sum__gqa_block_cached__dense_activation_squared_relu__decode'

def setup_inputs():

    _w = (lambda a: (lambda t: t.to(torch.bfloat16) if t.is_floating_point() else t)(torch.as_tensor(a)))
    def _A_setup():
        B, Sq, D = 8, 1, 1024
        Hq, Hkv, Sk, Dh = 32, 4, 4096, 128
        assert Hq % Hkv == 0, (Hq, Hkv)
        return {
            "x": _w((lambda *s: torch.randn(*s, dtype=torch.bfloat16) * 0.05)(B, Sq, D)),
            "k_cache": _w((lambda *s: torch.randn(*s, dtype=torch.bfloat16) * 1.6)(B, Hkv, Sk, Dh)),
            "v_cache": _w((lambda *s: torch.randn(*s, dtype=torch.bfloat16) * 3.2)(B, Hkv, Sk, Dh)),
            "wq": _w((lambda *s: torch.randn(*s, dtype=torch.bfloat16) * 1.6)(D, Hq * Dh) * (D ** -0.5)),
            "wo": _w((lambda *s: torch.randn(*s, dtype=torch.bfloat16) * 3.2)(Hq * Dh, D) * ((Hq * Dh) ** -0.5)),
        }
    _A_in = _A_setup()

    def _B_setup():
        B, S, D, F = 8, 1, 1024, 3584
        return {
            "x": _w((lambda *s: torch.randn(*s, dtype=torch.bfloat16) * 0.05)(B, S, D)),
            "w1": _w((lambda *s: torch.randn(*s, dtype=torch.bfloat16) * 0.05)(D, F)),
            "b1": _w((lambda *s: torch.randn(*s, dtype=torch.bfloat16) * 0.4)(F)),
            "w2": _w((lambda *s: torch.randn(*s, dtype=torch.bfloat16) * 0.05)(F, D)),
            "b2": _w((lambda *s: torch.randn(*s, dtype=torch.bfloat16) * 3.2)(D)),
        }
    _B_in = _B_setup()

    return {
        "A_x": _A_in["x"],
        "A_k_cache": _A_in["k_cache"],
        "A_v_cache": _A_in["v_cache"],
        "A_wq": _A_in["wq"],
        "A_wo": _A_in["wo"],
        "B_x": _B_in["x"],
        "B_w1": _B_in["w1"],
        "B_b1": _B_in["b1"],
        "B_w2": _B_in["w2"],
        "B_b2": _B_in["b2"],
    }

def reference(A_x, A_k_cache, A_v_cache, A_wq, A_wo, B_x, B_w1, B_b1, B_w2, B_b2):
    def _A_ref(x, k_cache, v_cache, wq, wo):
        B, Sq, D = x.shape
        Hq, Dh = 32, 128
        Hkv = k_cache.shape[1]
        rep = Hq // Hkv
        q = (lambda x, *d: x.permute(*d))((x @ wq).reshape(B, Sq, Hq, Dh), 0, 2, 1, 3)
        k = (lambda x, n, axis: torch.repeat_interleave(x, n, dim=axis))(k_cache, rep, axis=1)
        v = (lambda x, n, axis: torch.repeat_interleave(x, n, dim=axis))(v_cache, rep, axis=1)
        scores = torch.einsum("bhqd,bhkd->bhqk", q, k) * (Dh ** -0.5)
        p = _softmax(scores, axis=-1)
        o = torch.einsum("bhqk,bhkd->bhqd", p, v)
        return (lambda x, *d: x.permute(*d))(o, 0, 2, 1, 3).reshape(B, Sq, Hq * Dh) @ wo

    def _B_ref(x, w1, b1, w2, b2):
        h = torch.einsum("bsd,df->bsf", x, w1) + b1
        zero = torch.zeros_like(h)
        r = torch.where(h > zero, h, zero)
        h = r * r
        out = torch.einsum("bsf,fd->bsd", h, w2) + b2
        return out

    x = A_x
    xn = _layernorm(x, axis=-1)
    return x + _A_ref(xn, A_k_cache, A_v_cache, A_wq, A_wo) + _B_ref(xn, B_w1, B_b1, B_w2, B_b2)
```

```asm
; @launch grid=(256,1,1) block=(512,1,1) lds=163840
.amdgcn_target "amdgcn-amd-amdhsa--gfx950"
.text
.globl parallel_sum__gqa_block_cached__dense_activation_squared_relu__decode_kernel
.p2align 12
.p2align 8
.type parallel_sum__gqa_block_cached__dense_activation_squared_relu__decode_kernel,@function
parallel_sum__gqa_block_cached__dense_activation_squared_relu__decode_kernel:
    s_load_dwordx16 s[4:19], s[0:1], 0
    s_cmp_ge_u32 s2, 256
    s_cbranch_scc1 L_end
    s_load_dwordx8 s[20:27], s[0:1], 64
    s_load_dwordx2 s[28:29], s[0:1], 96
    v_lshrrev_b32 v2, 6, v0
    v_and_b32 v1, 63, v0
    v_readfirstlane_b32 s3, v2
    s_lshr_b32 s31, s2, 4
    s_xor_b32 s31, s31, s2
    s_and_b32 s30, s31, 7
    s_bfe_u32 s47, s2, 0x10003
    s_lshl1_add_u32 s30, s30, s47
    s_and_b32 s50, s2, 0xf0
    s_or_b32 s50, s50, s30
    s_mov_b32 s46, 7168
    s_cmp_lt_u32 s50, 128
    s_cselect_b32 s46, 8192, s46
    s_bfe_u32 s48, s50, 0x60001
    v_lshlrev_b32 v6, 4, v1
    s_cmp_ge_u32 s3, 4
    s_cbranch_scc1 L_compute
    s_lshl_b32 s31, s47, 9
    s_lshl_b32 s32, s3, 7
    s_add_u32 s31, s31, s32
    s_mul_i32 s31, s31, s46
    s_lshl_b32 s32, s48, 7
    s_add_u32 s53, s31, s32
    s_lshl_b32 s54, s46, 3
    s_lshl_b32 s55, s3, 15
    v_lshrrev_b32 v2, 3, v1
    v_and_b32 v3, 7, v1
    v_and_b32 v4, 2, v2
    v_xor_b32 v3, v3, v4
    v_lshlrev_b32 v3, 4, v3
    v_mul_lo_u32 v2, v2, s46
    v_add_u32 v12, v2, v3
    v_xor_b32 v3, 64, v3
    v_add_u32 v13, v2, v3
    s_lshl_b32 s66, s46, 10
    s_cmp_lt_u32 s50, 240
    s_cselect_b32 s66, s66, 0
    s_mov_b32 s67, 0x20000
    s_add_u32 m0, s55, 16384
    s_cmp_lt_u32 s50, 128
    s_waitcnt lgkmcnt(0)
    s_cselect_b64 s[64:65], s[10:11], s[16:17]
    buffer_load_dwordx4 v12, s[64:67], s53 offen nt lds
    s_addk_i32 m0, 1024
    s_add_u32 s53, s53, s54
    buffer_load_dwordx4 v13, s[64:67], s53 offen nt lds
    s_addk_i32 m0, 1024
    s_add_u32 s53, s53, s54
    buffer_load_dwordx4 v12, s[64:67], s53 offen nt lds
    s_addk_i32 m0, 1024
    s_add_u32 s53, s53, s54
    buffer_load_dwordx4 v13, s[64:67], s53 offen nt lds
    s_addk_i32 m0, 1024
    s_add_u32 s53, s53, s54
    buffer_load_dwordx4 v12, s[64:67], s53 offen nt lds
    s_addk_i32 m0, 1024
    s_add_u32 s53, s53, s54
    buffer_load_dwordx4 v13, s[64:67], s53 offen nt lds
    s_addk_i32 m0, 1024
    s_add_u32 s53, s53, s54
    s_load_dword s33, s[28:29], 0x90000
    s_mov_b32 s56, s6
    s_and_b32 s57, s7, 0xffff
    s_mov_b32 s58, 33554432
    s_mov_b32 s59, 0x20000
    s_mov_b32 s60, s8
    s_and_b32 s61, s9, 0xffff
    s_mov_b32 s62, 33554432
    s_mov_b32 s63, 0x20000
    s_mov_b32 s70, 7340032
    s_cmp_lt_u32 s2, 128
    s_cselect_b64 s[68:69], s[12:13], s[20:21]
    s_cselect_b32 s70, 8388608, s70
    s_mov_b32 s71, 0x20000
    s_mov_b32 s36, s28
    s_and_b32 s37, s29, 0xffff
    s_mov_b32 s38, 8388608
    s_mov_b32 s39, 0x20000
    s_mov_b32 s84, s26
    s_and_b32 s85, s27, 0xffff
    s_mov_b32 s86, 256
    s_mov_b32 s87, 0x20000
    s_cmp_ge_u32 s2, 240
    s_cselect_b32 s83, 32768, 0
    s_and_b32 s81, s2, 7
    s_lshl_b32 s81, s81, 5
    s_lshr_b32 s82, s2, 3
    s_add_u32 s82, s82, s81
    s_cmp_eq_u32 s3, 0
    s_cselect_b32 s82, s82, 268435456
    s_cmp_lt_u32 s2, 240
    s_cselect_b32 s82, s82, 268435456
    s_lshr_b32 s44, s2, 3
    s_and_b32 s45, s2, 7
    s_mov_b32 s34, 0x00ff00ff
    s_mov_b32 s35, 0x00ff00ff
    v_lshrrev_b32 v7, 4, v1
    v_and_b32 v8, 7, v1
    v_mov_b32 v9, 0xff
    v_mov_b32 v10, 0
    v_and_b32 v3, 15, v1
    v_lshlrev_b32 v4, 2, v7
    v_xor_b32 v3, v3, v4
    v_and_b32 v2, 1, v7
    v_lshlrev_b32 v2, 8, v2
    v_lshrrev_b32 v4, 1, v7
    v_lshl_add_u32 v2, v4, 11, v2
    v_bfi_b32 v14, v9, v6, v2
    v_xor_b32 v4, 0, v3
    v_lshl_add_u32 v16, v4, 4, v2
    v_xor_b32 v4, 1, v3
    v_lshl_add_u32 v17, v4, 4, v2
    v_xor_b32 v4, 2, v3
    v_lshl_add_u32 v18, v4, 4, v2
    v_xor_b32 v4, 3, v3
    v_lshl_add_u32 v19, v4, 4, v2
    s_and_b32 s73, s2, 31
    s_lshl_b32 s73, s73, 20
    s_lshr_b32 s30, s2, 5
    s_lshl_b32 s30, s30, 17
    s_add_u32 s73, s73, s30
    s_bitcmp1_b32 s3, 0
    s_cselect_b32 s30, 40960, 0
    s_xor_b32 s73, s73, s30
    s_bitcmp1_b32 s3, 1
    s_cselect_b32 s30, 81920, 0
    s_xor_b32 s73, s73, s30
    s_bitcmp1_b32 s2, 3
    s_cselect_b32 s30, 512, 0
    s_xor_b32 s73, s73, s30
    s_bitcmp1_b32 s2, 4
    s_cselect_b32 s30, 1024, 0
    s_xor_b32 s73, s73, s30
    s_bitcmp1_b32 s2, 5
    s_cselect_b32 s30, 4096, 0
    s_xor_b32 s73, s73, s30
    s_bitcmp1_b32 s2, 6
    s_cselect_b32 s30, 8192, 0
    s_xor_b32 s73, s73, s30
    s_bitcmp1_b32 s2, 7
    s_cselect_b32 s30, 16384, 0
    s_xor_b32 s73, s73, s30
    s_mov_b32 s72, 5
    s_waitcnt vmcnt(5)
    buffer_load_dwordx4 v12, s[64:67], s53 offen nt lds
    s_addk_i32 m0, 1024
    s_add_u32 s53, s53, s54
    v_and_b32 v3, 15, v1
    v_lshlrev_b32 v4, 1, v7
    v_xor_b32 v3, v3, v4
    s_lshl_b32 s30, s3, 2
    s_and_b32 s30, s30, 8
    v_xor_b32 v3, s30, v3
    v_lshlrev_b32 v3, 4, v3
    s_mov_b32 s76, 32768
    s_cmp_lt_u32 s2, 128
    s_cselect_b32 s32, 14, 11
    s_cselect_b32 s77, 262144, s76
    s_cselect_b32 s76, 0, s76
    v_lshl_add_u32 v11, v7, s32, v3
    s_cselect_b32 s32, 11, 13
    s_cselect_b32 s6, 7, 3
    s_cselect_b32 s31, 12, 13
    s_cselect_b32 s5, 1, 0
    s_cselect_b32 s30, s3, 0
    s_lshl_b32 s6, s6, s32
    s_lshl_b32 s5, s5, s32
    s_lshl_b32 s4, s3, s31
    s_and_b32 s4, s4, s6
    s_lshl_b32 s30, s30, 16
    s_and_b32 s31, s44, 15
    s_lshl_b32 s31, s31, 19
    s_add_u32 s30, s30, s31
    s_lshl_b32 s31, s45, 8
    s_add_u32 s75, s30, s31
    s_cmp_lt_u32 s2, 128
    s_cbranch_scc1 L_w2r
    s_add_u32 s75, s75, s4
    s_mov_b32 s5, 32768
    s_mov_b32 s6, 491520
    s_mul_i32 s4, s44, 32768
    s_and_b32 s4, s4, s6
    s_mov_b32 s76, 0
    s_mov_b32 s77, 0
L_w2r:
    s_and_b32 s30, s2, 192
    s_cmp_eq_u32 s30, 64
    s_cselect_b32 s30, 262144, 0
    s_add_u32 s75, s75, s30
    s_lshl_b32 s30, s30, 1
    s_sub_u32 s77, s77, s30
    s_lshl_b32 s78, s3, 10
    s_waitcnt vmcnt(5)
    buffer_load_dwordx4 v13, s[64:67], s53 offen nt lds
    s_addk_i32 m0, 1024
    s_add_u32 s53, s53, s54
    v_and_b32 v2, 15, v1
    v_mul_u32_u24 v2, 288, v2
    v_lshl_add_u32 v2, v7, 4, v2
    v_add_u32 v156, 141824, v2
    v_bfe_u32 v2, v1, 2, 2
    v_and_b32 v4, 1, v1
    v_lshlrev_b32 v4, 3, v4
    v_bfe_u32 v5, v1, 1, 1
    s_lshl_b32 s30, s3, 1
    v_or_b32 v5, s30, v5
    v_lshlrev_b32 v3, 1, v2
    v_xor_b32 v5, v5, v3
    v_lshl_add_u32 v3, v7, 3, v2
    v_lshl_add_u32 v3, v3, 8, v4
    v_and_b32 v157, 1, v7
    v_lshlrev_b32 v157, 3, v157
    v_xor_b32 v157, v157, v5
    v_lshl_add_u32 v157, v157, 4, v3
    v_lshlrev_b32 v2, 6, v8
    v_lshl_add_u32 v2, v7, 4, v2
    v_and_or_b32 v2, v1, 8, v2
    s_lshl_b32 s30, s45, 5
    s_add_u32 s30, s30, s44
    s_lshl3_add_u32 s30, s30, s3
    s_lshl_b32 s30, s30, 9
    s_add_u32 s30, s30, 2097152
    v_add_u32 v158, s30, v2
    s_waitcnt vmcnt(5)
    buffer_load_dwordx4 v12, s[64:67], s53 offen nt lds
    s_addk_i32 m0, 1024
    s_add_u32 s53, s53, s54
    v_mul_u32_u24 v2, 144, v7
    v_lshl_add_u32 v2, v8, 4, v2
    v_and_b32 v3, 8, v1
    v_mul_u32_u24 v3, 288, v3
    v_add_u32 v2, v2, v3
    s_mul_i32 s30, s3, 4608
    s_add_u32 s30, s30, 65536
    v_add_u32 v159, s30, v2
    v_lshlrev_b32 v2, 7, v7
    v_lshl_add_u32 v2, v8, 4, v2
    s_lshl_b32 s30, s3, 11
    s_add_u32 s30, s30, 146816
    v_add_u32 v162, s30, v2
    s_mov_b32 s7, 0x05040100
    s_mov_b32 s8, 0x07060302
    s_waitcnt vmcnt(5)
    buffer_load_dwordx4 v13, s[64:67], s53 offen nt lds
    s_addk_i32 m0, 1024
    s_add_u32 s53, s53, s54
    s_waitcnt vmcnt(4)
    buffer_load_dwordx4 v12, s[64:67], s53 offen nt lds
    s_addk_i32 m0, 1024
    s_add_u32 s53, s53, s54
    s_waitcnt vmcnt(4)
    buffer_load_dwordx4 v13, s[64:67], s53 offen nt lds
    s_addk_i32 m0, 1024
    s_add_u32 s53, s53, s54
    s_waitcnt vmcnt(4)
    buffer_load_dwordx4 v12, s[64:67], s53 offen nt lds
    s_addk_i32 m0, 1024
    s_add_u32 s53, s53, s54
    s_waitcnt vmcnt(4)
    buffer_load_dwordx4 v13, s[64:67], s53 offen nt lds
    s_addk_i32 m0, 1024
    s_add_u32 s53, s53, s54
    s_waitcnt vmcnt(4)
    buffer_load_dwordx4 v12, s[64:67], s53 offen nt lds
    s_addk_i32 m0, 1024
    s_add_u32 s53, s53, s54
    s_waitcnt vmcnt(4)
    s_mov_b32 s79, 5
    s_mov_b64 exec, 3
    v_mov_b32 v15, s79
    buffer_store_byte v15, off, s[84:87], s82
    buffer_load_dwordx4 v[148:151], v6, s[84:87], s81 offen nt
    s_mov_b64 exec, -1
    buffer_load_dwordx4 v13, s[64:67], s53 offen nt lds
    s_waitcnt vmcnt(6)
    s_xor_b32 s30, s73, 0
    s_add_u32 m0, s55, 0
    s_nop 0
    buffer_load_dwordx4 v16, s[56:59], s30 offen nt lds
    s_waitcnt vmcnt(6)
    s_xor_b32 s30, s73, 512
    s_add_u32 m0, s55, 1024
    s_nop 0
    buffer_load_dwordx4 v17, s[56:59], s30 offen nt lds
    s_waitcnt vmcnt(6)
    s_xor_b32 s30, s73, 1024
    s_add_u32 m0, s55, 2048
    s_nop 0
    buffer_load_dwordx4 v18, s[56:59], s30 offen nt lds
    s_waitcnt vmcnt(6)
    s_xor_b32 s30, s73, 1536
    s_add_u32 m0, s55, 3072
    s_nop 0
    buffer_load_dwordx4 v19, s[56:59], s30 offen nt lds
    s_waitcnt vmcnt(4)
    s_mov_b32 s80, 10
    s_mov_b64 exec, 3
    v_mov_b32 v15, s80
    buffer_store_byte v15, off, s[84:87], s82
    buffer_load_dwordx4 v[152:155], v6, s[84:87], s81 offen nt
    s_mov_b64 exec, -1
    s_xor_b32 s30, s73, 4096
    s_add_u32 m0, s55, 4096
    s_nop 0
    buffer_load_dwordx4 v16, s[56:59], s30 offen nt lds
    s_waitcnt vmcnt(7)
    s_waitcnt lgkmcnt(0)
    s_add_u32 s33, s33, 0xd1a7653b
    s_xor_b32 s33, s33, 0x80808080
    s_bfe_u32 s40, s33, 0x80000
    s_bfe_u32 s41, s33, 0x80008
    s_bfe_u32 s42, s33, 0x80010
    s_bfe_u32 s43, s33, 0x80018
    s_cmp_ge_u32 s2, 240
    s_cbranch_scc1 L_nbs
    s_barrier
L_nbs:
    s_waitcnt vmcnt(6)
    s_xor_b32 s30, s73, 4608
    s_add_u32 m0, s55, 5120
    s_nop 0
    buffer_load_dwordx4 v17, s[56:59], s30 offen nt lds
    v_mov_b32 v160, s42
    v_mov_b32 v161, s43
    s_mov_b64 exec, s[34:35]
    v_mov_b32 v160, s40
    v_mov_b32 v161, s41
    s_mov_b64 exec, -1
    v_mov_b32 v164, 0
    v_mov_b32 v165, 0
    v_mov_b32 v166, 0
    v_mov_b32 v167, 0
    v_mov_b32 v168, 0
    v_mov_b32 v169, 0
    v_mov_b32 v170, 0
    v_mov_b32 v171, 0
    v_mov_b32 v172, 0
    v_mov_b32 v173, 0
    v_mov_b32 v174, 0
    v_mov_b32 v175, 0
    v_mov_b32 v176, 0
    v_mov_b32 v177, 0
    v_mov_b32 v178, 0
    v_mov_b32 v179, 0
    s_waitcnt vmcnt(9)
    v_sad_u8 v148, v148, 0, 0
    v_sad_u8 v148, v149, 0, v148
    v_sad_u8 v148, v150, 0, v148
    v_sad_u8 v148, v151, 0, v148
    s_mul_i32 s32, s79, 30
    v_readlane_b32 s30, v148, 0
    v_readlane_b32 s31, v148, 1
    s_add_u32 s30, s30, s31
    s_sub_u32 s30, s30, s32
    s_mul_i32 s30, s30, 205
    s_add_u32 s30, s30, 55312
    s_lshl3_add_u32 s30, s83, s30
    s_ashr_i32 s30, s30, 13
    s_max_i32 s30, s30, 5
    s_min_i32 s72, s30, 8
    s_waitcnt vmcnt(11)
    s_cmp_ge_i32 s72, 8
    s_cbranch_scc1 L_deep22
    s_waitcnt vmcnt(8)
    s_cmp_ge_i32 s72, 7
    s_cbranch_scc1 L_deep22
    s_waitcnt vmcnt(7)
    s_cmp_ge_i32 s72, 6
    s_cbranch_scc1 L_deep22
    s_waitcnt vmcnt(6)
L_deep22:
    s_xor_b32 s30, s73, 5120
    s_add_u32 m0, s55, 6144
    s_nop 0
    buffer_load_dwordx4 v18, s[56:59], s30 offen nt lds
    v_mov_b32 v180, 0
    v_mov_b32 v181, 0
    v_mov_b32 v182, 0
    v_mov_b32 v183, 0
    v_mov_b32 v184, 0
    v_mov_b32 v185, 0
    v_mov_b32 v186, 0
    v_mov_b32 v187, 0
    v_mov_b32 v188, 0
    v_mov_b32 v189, 0
    v_mov_b32 v190, 0
    v_mov_b32 v191, 0
    v_mov_b32 v192, 0
    v_mov_b32 v193, 0
    v_mov_b32 v194, 0
    v_mov_b32 v195, 0
    s_waitcnt vmcnt(9)
    s_cmp_ge_i32 s72, 8
    s_cbranch_scc1 L_deep23
    s_waitcnt vmcnt(8)
    s_cmp_ge_i32 s72, 7
    s_cbranch_scc1 L_deep23
    s_waitcnt vmcnt(7)
    s_cmp_ge_i32 s72, 6
    s_cbranch_scc1 L_deep23
    s_waitcnt vmcnt(6)
L_deep23:
    s_xor_b32 s30, s73, 5632
    s_add_u32 m0, s55, 7168
    s_nop 0
    buffer_load_dwordx4 v19, s[56:59], s30 offen nt lds
    s_waitcnt vmcnt(9)
    s_cmp_ge_i32 s72, 8
    s_cbranch_scc1 L_deep24
    s_waitcnt vmcnt(8)
    s_cmp_ge_i32 s72, 7
    s_cbranch_scc1 L_deep24
    s_waitcnt vmcnt(7)
    s_cmp_ge_i32 s72, 6
    s_cbranch_scc1 L_deep24
    s_waitcnt vmcnt(6)
L_deep24:
    s_xor_b32 s30, s73, 8192
    s_add_u32 m0, s55, 8192
    s_nop 0
    buffer_load_dwordx4 v16, s[56:59], s30 offen nt lds
    s_cmp_ge_u32 s2, 240
    s_cbranch_scc1 L_nb2
    s_barrier
L_nb2:
    s_waitcnt vmcnt(9)
    s_cmp_ge_i32 s72, 8
    s_cbranch_scc1 L_deep25
    s_waitcnt vmcnt(8)
    s_cmp_ge_i32 s72, 7
    s_cbranch_scc1 L_deep25
    s_waitcnt vmcnt(7)
    s_cmp_ge_i32 s72, 6
    s_cbranch_scc1 L_deep25
    s_waitcnt vmcnt(4)
L_deep25:
    s_sub_u32 s79, 20, s72
    s_mov_b64 exec, 3
    v_mov_b32 v15, s79
    buffer_store_byte v15, off, s[84:87], s82
    buffer_load_dwordx4 v[148:151], v6, s[84:87], s81 offen nt
    s_mov_b64 exec, -1
    s_xor_b32 s30, s73, 8704
    s_add_u32 m0, s55, 9216
    s_nop 0
    buffer_load_dwordx4 v17, s[56:59], s30 offen nt lds
    s_waitcnt vmcnt(11)
    s_cmp_ge_i32 s72, 8
    s_cbranch_scc1 L_deep26
    s_waitcnt vmcnt(10)
    s_cmp_ge_i32 s72, 7
    s_cbranch_scc1 L_deep26
    s_waitcnt vmcnt(7)
    s_cmp_ge_i32 s72, 6
    s_cbranch_scc1 L_deep26
    s_waitcnt vmcnt(6)
L_deep26:
    s_xor_b32 s30, s73, 9216
    s_add_u32 m0, s55, 10240
    s_nop 0
    buffer_load_dwordx4 v18, s[56:59], s30 offen nt lds
    s_waitcnt vmcnt(9)
    v_sad_u8 v152, v152, 0, 0
    v_sad_u8 v152, v153, 0, v152
    v_sad_u8 v152, v154, 0, v152
    v_sad_u8 v152, v155, 0, v152
    s_mul_i32 s32, s80, 30
    v_readlane_b32 s30, v152, 0
    v_readlane_b32 s31, v152, 1
    s_add_u32 s30, s30, s31
    s_sub_u32 s30, s30, s32
    s_mul_i32 s30, s30, 205
    s_add_u32 s30, s30, 55312
    s_lshl3_add_u32 s30, s83, s30
    s_ashr_i32 s30, s30, 13
    s_max_i32 s30, s30, 5
    s_min_i32 s72, s30, 8
    s_waitcnt vmcnt(11)
    s_cmp_ge_i32 s72, 8
    s_cbranch_scc1 L_deep27
    s_waitcnt vmcnt(8)
    s_cmp_ge_i32 s72, 7
    s_cbranch_scc1 L_deep27
    s_waitcnt vmcnt(7)
    s_cmp_ge_i32 s72, 6
    s_cbranch_scc1 L_deep27
    s_waitcnt vmcnt(6)
L_deep27:
    s_xor_b32 s30, s73, 9728
    s_add_u32 m0, s55, 11264
    s_nop 0
    buffer_load_dwordx4 v19, s[56:59], s30 offen nt lds
    s_waitcnt vmcnt(9)
    s_cmp_ge_i32 s72, 8
    s_cbranch_scc1 L_deep28
    s_waitcnt vmcnt(8)
    s_cmp_ge_i32 s72, 7
    s_cbranch_scc1 L_deep28
    s_waitcnt vmcnt(7)
    s_cmp_ge_i32 s72, 6
    s_cbranch_scc1 L_deep28
    s_waitcnt vmcnt(6)
L_deep28:
    s_xor_b32 s30, s73, 12288
    s_add_u32 m0, s55, 12288
    s_nop 0
    buffer_load_dwordx4 v16, s[56:59], s30 offen nt lds
    s_waitcnt vmcnt(9)
    s_cmp_ge_i32 s72, 8
    s_cbranch_scc1 L_deep29
    s_waitcnt vmcnt(8)
    s_cmp_ge_i32 s72, 7
    s_cbranch_scc1 L_deep29
    s_waitcnt vmcnt(7)
    s_cmp_ge_i32 s72, 6
    s_cbranch_scc1 L_deep29
    s_waitcnt vmcnt(6)
L_deep29:
    s_xor_b32 s30, s73, 12800
    s_add_u32 m0, s55, 13312
    s_nop 0
    buffer_load_dwordx4 v17, s[56:59], s30 offen nt lds
    s_waitcnt vmcnt(9)
    s_cmp_ge_i32 s72, 8
    s_cbranch_scc1 L_deep30
    s_waitcnt vmcnt(8)
    s_cmp_ge_i32 s72, 7
    s_cbranch_scc1 L_deep30
    s_waitcnt vmcnt(7)
    s_cmp_ge_i32 s72, 6
    s_cbranch_scc1 L_deep30
    s_waitcnt vmcnt(4)
L_deep30:
    s_sub_u32 s80, 25, s72
    s_mov_b64 exec, 3
    v_mov_b32 v15, s80
    buffer_store_byte v15, off, s[84:87], s82
    buffer_load_dwordx4 v[152:155], v6, s[84:87], s81 offen nt
    s_mov_b64 exec, -1
    s_xor_b32 s30, s73, 13312
    s_add_u32 m0, s55, 14336
    s_nop 0
    buffer_load_dwordx4 v18, s[56:59], s30 offen nt lds
    s_waitcnt vmcnt(11)
    s_cmp_ge_i32 s72, 8
    s_cbranch_scc1 L_deep31
    s_waitcnt vmcnt(10)
    s_cmp_ge_i32 s72, 7
    s_cbranch_scc1 L_deep31
    s_waitcnt vmcnt(7)
    s_cmp_ge_i32 s72, 6
    s_cbranch_scc1 L_deep31
    s_waitcnt vmcnt(6)
L_deep31:
    s_xor_b32 s30, s73, 13824
    s_add_u32 m0, s55, 15360
    s_nop 0
    buffer_load_dwordx4 v19, s[56:59], s30 offen nt lds
    s_branch L_pb_l0
    .p2align 12
L_pad_l0:
    s_branch L_ret_l0
L_pb_l0:
    s_waitcnt vmcnt(9)
    v_sad_u8 v148, v148, 0, 0
    v_sad_u8 v148, v149, 0, v148
    v_sad_u8 v148, v150, 0, v148
    v_sad_u8 v148, v151, 0, v148
    s_mul_i32 s32, s79, 30
    v_readlane_b32 s30, v148, 0
    v_readlane_b32 s31, v148, 1
    s_add_u32 s30, s30, s31
    s_sub_u32 s30, s30, s32
    s_mul_i32 s30, s30, 205
    s_add_u32 s30, s30, 55312
    s_lshl3_add_u32 s30, s83, s30
    s_ashr_i32 s30, s30, 13
    s_max_i32 s30, s30, 5
    s_min_i32 s72, s30, 8
    s_waitcnt vmcnt(11)
    s_cmp_ge_i32 s72, 8
    s_cbranch_scc1 L_deep32
    s_waitcnt vmcnt(8)
    s_cmp_ge_i32 s72, 7
    s_cbranch_scc1 L_deep32
    s_waitcnt vmcnt(7)
    s_cmp_ge_i32 s72, 6
    s_cbranch_scc1 L_deep32
    s_waitcnt vmcnt(6)
L_deep32:
    s_xor_b32 s30, s73, 16384
    s_add_u32 m0, s55, 16384
    s_nop 0
    buffer_load_dwordx4 v16, s[56:59], s30 offen nt lds
    s_waitcnt vmcnt(9)
    s_cmp_ge_i32 s72, 8
    s_cbranch_scc1 L_deep33
    s_waitcnt vmcnt(8)
    s_cmp_ge_i32 s72, 7
    s_cbranch_scc1 L_deep33
    s_waitcnt vmcnt(7)
    s_cmp_ge_i32 s72, 6
    s_cbranch_scc1 L_deep33
    s_waitcnt vmcnt(6)
L_deep33:
    s_xor_b32 s30, s73, 16896
    s_add_u32 m0, s55, 17408
    s_nop 0
    buffer_load_dwordx4 v17, s[56:59], s30 offen nt lds
    s_waitcnt vmcnt(9)
    s_cmp_ge_i32 s72, 8
    s_cbranch_scc1 L_deep34
    s_waitcnt vmcnt(8)
    s_cmp_ge_i32 s72, 7
    s_cbranch_scc1 L_deep34
    s_waitcnt vmcnt(7)
    s_cmp_ge_i32 s72, 6
    s_cbranch_scc1 L_deep34
    s_waitcnt vmcnt(6)
L_deep34:
    s_xor_b32 s30, s73, 17408
    s_add_u32 m0, s55, 18432
    s_nop 0
    buffer_load_dwordx4 v18, s[56:59], s30 offen nt lds
    s_cmp_lt_u32 s2, 240
    s_cbranch_scc1 L_nox
    s_barrier
    s_barrier
    s_barrier
L_nox:
    s_waitcnt vmcnt(9)
    s_cmp_ge_i32 s72, 8
    s_cbranch_scc1 L_deep35
    s_waitcnt vmcnt(8)
    s_cmp_ge_i32 s72, 7
    s_cbranch_scc1 L_deep35
    s_waitcnt vmcnt(7)
    s_cmp_ge_i32 s72, 6
    s_cbranch_scc1 L_deep35
    s_waitcnt vmcnt(4)
L_deep35:
    s_sub_u32 s79, 30, s72
    s_mov_b64 exec, 3
    v_mov_b32 v15, s79
    buffer_store_byte v15, off, s[84:87], s82
    buffer_load_dwordx4 v[148:151], v6, s[84:87], s81 offen nt
    s_mov_b64 exec, -1
    s_xor_b32 s30, s73, 17920
    s_add_u32 m0, s55, 19456
    s_nop 0
    buffer_load_dwordx4 v19, s[56:59], s30 offen nt lds
    s_waitcnt vmcnt(11)
    s_cmp_ge_i32 s72, 8
    s_cbranch_scc1 L_deep36
    s_waitcnt vmcnt(10)
    s_cmp_ge_i32 s72, 7
    s_cbranch_scc1 L_deep36
    s_waitcnt vmcnt(7)
    s_cmp_ge_i32 s72, 6
    s_cbranch_scc1 L_deep36
    s_waitcnt vmcnt(6)
L_deep36:
    s_xor_b32 s30, s73, 20480
    s_add_u32 m0, s55, 20480
    s_nop 0
    buffer_load_dwordx4 v16, s[56:59], s30 offen nt lds
    s_waitcnt vmcnt(9)
    v_sad_u8 v152, v152, 0, 0
    v_sad_u8 v152, v153, 0, v152
    v_sad_u8 v152, v154, 0, v152
    v_sad_u8 v152, v155, 0, v152
    s_mul_i32 s32, s80, 30
    v_readlane_b32 s30, v152, 0
    v_readlane_b32 s31, v152, 1
    s_add_u32 s30, s30, s31
    s_sub_u32 s30, s30, s32
    s_mul_i32 s30, s30, 205
    s_add_u32 s30, s30, 55312
    s_lshl3_add_u32 s30, s83, s30
    s_ashr_i32 s30, s30, 13
    s_max_i32 s30, s30, 5
    s_min_i32 s72, s30, 8
    s_waitcnt vmcnt(11)
    s_cmp_ge_i32 s72, 8
    s_cbranch_scc1 L_deep37
    s_waitcnt vmcnt(8)
    s_cmp_ge_i32 s72, 7
    s_cbranch_scc1 L_deep37
    s_waitcnt vmcnt(7)
    s_cmp_ge_i32 s72, 6
    s_cbranch_scc1 L_deep37
    s_waitcnt vmcnt(6)
L_deep37:
    s_xor_b32 s30, s73, 20992
    s_add_u32 m0, s55, 21504
    s_nop 0
    buffer_load_dwordx4 v17, s[56:59], s30 offen nt lds
    s_waitcnt vmcnt(9)
    s_cmp_ge_i32 s72, 8
    s_cbranch_scc1 L_deep38
    s_waitcnt vmcnt(8)
    s_cmp_ge_i32 s72, 7
    s_cbranch_scc1 L_deep38
    s_waitcnt vmcnt(7)
    s_cmp_ge_i32 s72, 6
    s_cbranch_scc1 L_deep38
    s_waitcnt vmcnt(6)
L_deep38:
    s_xor_b32 s30, s73, 21504
    s_add_u32 m0, s55, 22528
    s_nop 0
    buffer_load_dwordx4 v18, s[56:59], s30 offen nt lds
    s_waitcnt vmcnt(9)
    s_cmp_ge_i32 s72, 8
    s_cbranch_scc1 L_deep39
    s_waitcnt vmcnt(8)
    s_cmp_ge_i32 s72, 7
    s_cbranch_scc1 L_deep39
    s_waitcnt vmcnt(7)
    s_cmp_ge_i32 s72, 6
    s_cbranch_scc1 L_deep39
    s_waitcnt vmcnt(6)
L_deep39:
    s_xor_b32 s30, s73, 22016
    s_add_u32 m0, s55, 23552
    s_nop 0
    buffer_load_dwordx4 v19, s[56:59], s30 offen nt lds
    s_waitcnt vmcnt(9)
    s_cmp_ge_i32 s72, 8
    s_cbranch_scc1 L_deep40
    s_waitcnt vmcnt(8)
    s_cmp_ge_i32 s72, 7
    s_cbranch_scc1 L_deep40
    s_waitcnt vmcnt(7)
    s_cmp_ge_i32 s72, 6
    s_cbranch_scc1 L_deep40
    s_waitcnt vmcnt(4)
L_deep40:
    s_sub_u32 s80, 35, s72
    s_mov_b64 exec, 3
    v_mov_b32 v15, s80
    buffer_store_byte v15, off, s[84:87], s82
    buffer_load_dwordx4 v[152:155], v6, s[84:87], s81 offen nt
    s_mov_b64 exec, -1
    s_xor_b32 s30, s73, 24576
    s_add_u32 m0, s55, 24576
    s_nop 0
    buffer_load_dwordx4 v16, s[56:59], s30 offen nt lds
    s_waitcnt vmcnt(11)
    s_cmp_ge_i32 s72, 8
    s_cbranch_scc1 L_deep41
    s_waitcnt vmcnt(10)
    s_cmp_ge_i32 s72, 7
    s_cbranch_scc1 L_deep41
    s_waitcnt vmcnt(7)
    s_cmp_ge_i32 s72, 6
    s_cbranch_scc1 L_deep41
    s_waitcnt vmcnt(6)
L_deep41:
    s_xor_b32 s30, s73, 25088
    s_add_u32 m0, s55, 25600
    s_nop 0
    buffer_load_dwordx4 v17, s[56:59], s30 offen nt lds
    s_waitcnt vmcnt(9)
    v_sad_u8 v148, v148, 0, 0
    v_sad_u8 v148, v149, 0, v148
    v_sad_u8 v148, v150, 0, v148
    v_sad_u8 v148, v151, 0, v148
    s_mul_i32 s32, s79, 30
    v_readlane_b32 s30, v148, 0
    v_readlane_b32 s31, v148, 1
    s_add_u32 s30, s30, s31
    s_sub_u32 s30, s30, s32
    s_mul_i32 s30, s30, 205
    s_add_u32 s30, s30, 55312
    s_lshl3_add_u32 s30, s83, s30
    s_ashr_i32 s30, s30, 13
    s_max_i32 s30, s30, 5
    s_min_i32 s72, s30, 8
    s_waitcnt vmcnt(11)
    s_cmp_ge_i32 s72, 8
    s_cbranch_scc1 L_deep42
    s_waitcnt vmcnt(8)
    s_cmp_ge_i32 s72, 7
    s_cbranch_scc1 L_deep42
    s_waitcnt vmcnt(7)
    s_cmp_ge_i32 s72, 6
    s_cbranch_scc1 L_deep42
    s_waitcnt vmcnt(6)
L_deep42:
    s_xor_b32 s30, s73, 25600
    s_add_u32 m0, s55, 26624
    s_nop 0
    buffer_load_dwordx4 v18, s[56:59], s30 offen nt lds
    s_waitcnt vmcnt(9)
    s_cmp_ge_i32 s72, 8
    s_cbranch_scc1 L_deep43
    s_waitcnt vmcnt(8)
    s_cmp_ge_i32 s72, 7
    s_cbranch_scc1 L_deep43
    s_waitcnt vmcnt(7)
    s_cmp_ge_i32 s72, 6
    s_cbranch_scc1 L_deep43
    s_waitcnt vmcnt(6)
L_deep43:
    s_xor_b32 s30, s73, 26112
    s_add_u32 m0, s55, 27648
    s_nop 0
    buffer_load_dwordx4 v19, s[56:59], s30 offen nt lds
    s_waitcnt vmcnt(9)
    s_cmp_ge_i32 s72, 8
    s_cbranch_scc1 L_deep44
    s_waitcnt vmcnt(8)
    s_cmp_ge_i32 s72, 7
    s_cbranch_scc1 L_deep44
    s_waitcnt vmcnt(7)
    s_cmp_ge_i32 s72, 6
    s_cbranch_scc1 L_deep44
    s_waitcnt vmcnt(6)
L_deep44:
    s_xor_b32 s30, s73, 28672
    s_add_u32 m0, s55, 28672
    s_nop 0
    buffer_load_dwordx4 v16, s[56:59], s30 offen nt lds
    s_waitcnt vmcnt(9)
    s_cmp_ge_i32 s72, 8
    s_cbranch_scc1 L_deep45
    s_waitcnt vmcnt(8)
    s_cmp_ge_i32 s72, 7
    s_cbranch_scc1 L_deep45
    s_waitcnt vmcnt(7)
    s_cmp_ge_i32 s72, 6
    s_cbranch_scc1 L_deep45
    s_waitcnt vmcnt(4)
L_deep45:
    s_sub_u32 s79, 40, s72
    s_mov_b64 exec, 3
    v_mov_b32 v15, s79
    buffer_store_byte v15, off, s[84:87], s82
    buffer_load_dwordx4 v[148:151], v6, s[84:87], s81 offen nt
    s_mov_b64 exec, -1
    s_xor_b32 s30, s73, 29184
    s_add_u32 m0, s55, 29696
    s_nop 0
    buffer_load_dwordx4 v17, s[56:59], s30 offen nt lds
    s_waitcnt vmcnt(11)
    s_cmp_ge_i32 s72, 8
    s_cbranch_scc1 L_deep46
    s_waitcnt vmcnt(10)
    s_cmp_ge_i32 s72, 7
    s_cbranch_scc1 L_deep46
    s_waitcnt vmcnt(7)
    s_cmp_ge_i32 s72, 6
    s_cbranch_scc1 L_deep46
    s_waitcnt vmcnt(6)
L_deep46:
    s_xor_b32 s30, s73, 29696
    s_add_u32 m0, s55, 30720
    s_nop 0
    buffer_load_dwordx4 v18, s[56:59], s30 offen nt lds
    s_waitcnt vmcnt(9)
    v_sad_u8 v152, v152, 0, 0
    v_sad_u8 v152, v153, 0, v152
    v_sad_u8 v152, v154, 0, v152
    v_sad_u8 v152, v155, 0, v152
    s_mul_i32 s32, s80, 30
    v_readlane_b32 s30, v152, 0
    v_readlane_b32 s31, v152, 1
    s_add_u32 s30, s30, s31
    s_sub_u32 s30, s30, s32
    s_mul_i32 s30, s30, 205
    s_add_u32 s30, s30, 55312
    s_lshl3_add_u32 s30, s83, s30
    s_ashr_i32 s30, s30, 13
    s_max_i32 s30, s30, 5
    s_min_i32 s72, s30, 8
    s_waitcnt vmcnt(11)
    s_cmp_ge_i32 s72, 8
    s_cbranch_scc1 L_deep47
    s_waitcnt vmcnt(8)
    s_cmp_ge_i32 s72, 7
    s_cbranch_scc1 L_deep47
    s_waitcnt vmcnt(7)
    s_cmp_ge_i32 s72, 6
    s_cbranch_scc1 L_deep47
    s_waitcnt vmcnt(6)
L_deep47:
    s_xor_b32 s30, s73, 30208
    s_add_u32 m0, s55, 31744
    s_nop 0
    buffer_load_dwordx4 v19, s[56:59], s30 offen nt lds
    s_waitcnt vmcnt(9)
    s_cmp_ge_i32 s72, 8
    s_cbranch_scc1 L_deep48
    s_waitcnt vmcnt(8)
    s_cmp_ge_i32 s72, 7
    s_cbranch_scc1 L_deep48
    s_waitcnt vmcnt(7)
    s_cmp_ge_i32 s72, 6
    s_cbranch_scc1 L_deep48
    s_waitcnt vmcnt(6)
L_deep48:
    s_xor_b32 s30, s73, 0
    buffer_load_dwordx4 v[20:23], v14, s[60:63], s30 offen nt
    s_waitcnt vmcnt(9)
    s_cmp_ge_i32 s72, 8
    s_cbranch_scc1 L_deep49
    s_waitcnt vmcnt(8)
    s_cmp_ge_i32 s72, 7
    s_cbranch_scc1 L_deep49
    s_waitcnt vmcnt(7)
    s_cmp_ge_i32 s72, 6
    s_cbranch_scc1 L_deep49
    s_waitcnt vmcnt(6)
L_deep49:
    s_xor_b32 s30, s73, 512
    buffer_load_dwordx4 v[24:27], v14, s[60:63], s30 offen nt
    s_waitcnt vmcnt(9)
    s_cmp_ge_i32 s72, 8
    s_cbranch_scc1 L_deep50
    s_waitcnt vmcnt(8)
    s_cmp_ge_i32 s72, 7
    s_cbranch_scc1 L_deep50
    s_waitcnt vmcnt(7)
    s_cmp_ge_i32 s72, 6
    s_cbranch_scc1 L_deep50
    s_waitcnt vmcnt(4)
L_deep50:
    s_sub_u32 s80, 45, s72
    s_mov_b64 exec, 3
    v_mov_b32 v15, s80
    buffer_store_byte v15, off, s[84:87], s82
    buffer_load_dwordx4 v[152:155], v6, s[84:87], s81 offen nt
    s_mov_b64 exec, -1
    s_xor_b32 s30, s73, 1024
    buffer_load_dwordx4 v[28:31], v14, s[60:63], s30 offen nt
    s_waitcnt vmcnt(11)
    s_cmp_ge_i32 s72, 8
    s_cbranch_scc1 L_deep51
    s_waitcnt vmcnt(10)
    s_cmp_ge_i32 s72, 7
    s_cbranch_scc1 L_deep51
    s_waitcnt vmcnt(7)
    s_cmp_ge_i32 s72, 6
    s_cbranch_scc1 L_deep51
    s_waitcnt vmcnt(6)
L_deep51:
    s_xor_b32 s30, s73, 1536
    buffer_load_dwordx4 v[32:35], v14, s[60:63], s30 offen nt
    s_waitcnt vmcnt(9)
    v_sad_u8 v148, v148, 0, 0
    v_sad_u8 v148, v149, 0, v148
    v_sad_u8 v148, v150, 0, v148
    v_sad_u8 v148, v151, 0, v148
    s_mul_i32 s32, s79, 30
    v_readlane_b32 s30, v148, 0
    v_readlane_b32 s31, v148, 1
    s_add_u32 s30, s30, s31
    s_sub_u32 s30, s30, s32
    s_mul_i32 s30, s30, 205
    s_add_u32 s30, s30, 55312
    s_add_u32 s30, s30, s83
    s_ashr_i32 s30, s30, 13
    s_max_i32 s30, s30, 5
    s_min_i32 s72, s30, 8
    s_waitcnt vmcnt(11)
    s_cmp_ge_i32 s72, 8
    s_cbranch_scc1 L_deep52
    s_waitcnt vmcnt(8)
    s_cmp_ge_i32 s72, 7
    s_cbranch_scc1 L_deep52
    s_waitcnt vmcnt(7)
    s_cmp_ge_i32 s72, 6
    s_cbranch_scc1 L_deep52
    s_waitcnt vmcnt(6)
L_deep52:
    s_xor_b32 s30, s73, 4096
    buffer_load_dwordx4 v[36:39], v14, s[60:63], s30 offen nt
    s_barrier
    s_waitcnt vmcnt(9)
    s_cmp_ge_i32 s72, 8
    s_cbranch_scc1 L_deep53
    s_waitcnt vmcnt(8)
    s_cmp_ge_i32 s72, 7
    s_cbranch_scc1 L_deep53
    s_waitcnt vmcnt(7)
    s_cmp_ge_i32 s72, 6
    s_cbranch_scc1 L_deep53
    s_waitcnt vmcnt(6)
L_deep53:
    s_xor_b32 s30, s73, 4608
    buffer_load_dwordx4 v[40:43], v14, s[60:63], s30 offen nt
    s_waitcnt vmcnt(9)
    s_cmp_ge_i32 s72, 8
    s_cbranch_scc1 L_deep54
    s_waitcnt vmcnt(8)
    s_cmp_ge_i32 s72, 7
    s_cbranch_scc1 L_deep54
    s_waitcnt vmcnt(7)
    s_cmp_ge_i32 s72, 6
    s_cbranch_scc1 L_deep54
    s_waitcnt vmcnt(6)
L_deep54:
    s_xor_b32 s30, s73, 5120
    buffer_load_dwordx4 v[44:47], v14, s[60:63], s30 offen nt
    s_waitcnt vmcnt(9)
    s_cmp_ge_i32 s72, 8
    s_cbranch_scc1 L_deep55
    s_waitcnt vmcnt(8)
    s_cmp_ge_i32 s72, 7
    s_cbranch_scc1 L_deep55
    s_waitcnt vmcnt(7)
    s_cmp_ge_i32 s72, 6
    s_cbranch_scc1 L_deep55
    s_waitcnt vmcnt(4)
L_deep55:
    s_sub_u32 s79, 50, s72
    s_mov_b64 exec, 3
    v_mov_b32 v15, s79
    buffer_store_byte v15, off, s[84:87], s82
    buffer_load_dwordx4 v[148:151], v6, s[84:87], s81 offen nt
    s_mov_b64 exec, -1
    s_xor_b32 s30, s73, 5632
    buffer_load_dwordx4 v[48:51], v14, s[60:63], s30 offen nt
    s_waitcnt vmcnt(12)
    s_waitcnt vmcnt(11)
    s_cmp_ge_i32 s72, 8
    s_cbranch_scc1 L_deep56
    s_waitcnt vmcnt(10)
    s_cmp_ge_i32 s72, 7
    s_cbranch_scc1 L_deep56
    s_waitcnt vmcnt(7)
    s_cmp_ge_i32 s72, 6
    s_cbranch_scc1 L_deep56
    s_waitcnt vmcnt(6)
L_deep56:
    s_xor_b32 s30, s73, 8192
    buffer_load_dwordx4 v[52:55], v14, s[60:63], s30 offen nt
    s_waitcnt vmcnt(9)
    v_sad_u8 v152, v152, 0, 0
    v_sad_u8 v152, v153, 0, v152
    v_sad_u8 v152, v154, 0, v152
    v_sad_u8 v152, v155, 0, v152
    s_mul_i32 s32, s80, 30
    v_readlane_b32 s30, v152, 0
    v_readlane_b32 s31, v152, 1
    s_add_u32 s30, s30, s31
    s_sub_u32 s30, s30, s32
    s_mul_i32 s30, s30, 205
    s_add_u32 s30, s30, 55312
    s_add_u32 s30, s30, s83
    s_ashr_i32 s30, s30, 13
    s_max_i32 s30, s30, 5
    s_min_i32 s72, s30, 8
    s_waitcnt vmcnt(11)
    s_cmp_ge_i32 s72, 8
    s_cbranch_scc1 L_deep57
    s_waitcnt vmcnt(8)
    s_cmp_ge_i32 s72, 7
    s_cbranch_scc1 L_deep57
    s_waitcnt vmcnt(7)
    s_cmp_ge_i32 s72, 6
    s_cbranch_scc1 L_deep57
    s_waitcnt vmcnt(6)
L_deep57:
    s_xor_b32 s30, s73, 8704
    buffer_load_dwordx4 v[56:59], v14, s[60:63], s30 offen nt
    s_waitcnt vmcnt(9)
    s_cmp_ge_i32 s72, 8
    s_cbranch_scc1 L_deep58
    s_waitcnt vmcnt(8)
    s_cmp_ge_i32 s72, 7
    s_cbranch_scc1 L_deep58
    s_waitcnt vmcnt(7)
    s_cmp_ge_i32 s72, 6
    s_cbranch_scc1 L_deep58
    s_waitcnt vmcnt(6)
L_deep58:
    s_xor_b32 s30, s73, 9216
    buffer_load_dwordx4 v[60:63], v14, s[60:63], s30 offen nt
    s_waitcnt vmcnt(9)
    s_cmp_ge_i32 s72, 8
    s_cbranch_scc1 L_deep59
    s_waitcnt vmcnt(8)
    s_cmp_ge_i32 s72, 7
    s_cbranch_scc1 L_deep59
    s_waitcnt vmcnt(7)
    s_cmp_ge_i32 s72, 6
    s_cbranch_scc1 L_deep59
    s_waitcnt vmcnt(6)
L_deep59:
    s_xor_b32 s30, s73, 9728
    buffer_load_dwordx4 v[64:67], v14, s[60:63], s30 offen nt
    s_barrier
    s_waitcnt vmcnt(14)
    v_perm_b32 v196, v24, v20, s7
    v_perm_b32 v200, v24, v20, s8
    v_perm_b32 v204, v25, v21, s7
    v_perm_b32 v208, v25, v21, s8
    v_perm_b32 v212, v26, v22, s7
    v_perm_b32 v216, v26, v22, s8
    v_perm_b32 v220, v27, v23, s7
    v_perm_b32 v224, v27, v23, s8
    s_waitcnt vmcnt(10)
    v_perm_b32 v197, v32, v28, s7
    v_perm_b32 v201, v32, v28, s8
    v_perm_b32 v205, v33, v29, s7
    v_perm_b32 v209, v33, v29, s8
    v_perm_b32 v213, v34, v30, s7
    v_perm_b32 v217, v34, v30, s8
    v_perm_b32 v221, v35, v31, s7
    v_perm_b32 v225, v35, v31, s8
    s_waitcnt vmcnt(9)
    s_cmp_ge_i32 s72, 8
    s_cbranch_scc1 L_deep60
    s_waitcnt vmcnt(8)
    s_cmp_ge_i32 s72, 7
    s_cbranch_scc1 L_deep60
    s_waitcnt vmcnt(7)
    s_cmp_ge_i32 s72, 6
    s_cbranch_scc1 L_deep60
    s_waitcnt vmcnt(4)
L_deep60:
    s_sub_u32 s80, 55, s72
    s_mov_b64 exec, 3
    v_mov_b32 v15, s80
    buffer_store_byte v15, off, s[84:87], s82
    buffer_load_dwordx4 v[152:155], v6, s[84:87], s81 offen nt
    s_mov_b64 exec, -1
    s_xor_b32 s30, s73, 12288
    buffer_load_dwordx4 v[68:71], v14, s[60:63], s30 offen nt
    s_branch L_pb_l1
    .p2align 12
L_pad_l1:
    s_branch L_ret_l1
L_pb_l1:
    s_waitcnt vmcnt(11)
    s_cmp_ge_i32 s72, 8
    s_cbranch_scc1 L_deep61
    s_waitcnt vmcnt(10)
    s_cmp_ge_i32 s72, 7
    s_cbranch_scc1 L_deep61
    s_waitcnt vmcnt(7)
    s_cmp_ge_i32 s72, 6
    s_cbranch_scc1 L_deep61
    s_waitcnt vmcnt(6)
L_deep61:
    s_xor_b32 s30, s73, 12800
    buffer_load_dwordx4 v[72:75], v14, s[60:63], s30 offen nt
    s_waitcnt vmcnt(12)
    v_perm_b32 v198, v40, v36, s7
    v_perm_b32 v202, v40, v36, s8
    v_perm_b32 v206, v41, v37, s7
    v_perm_b32 v210, v41, v37, s8
    v_perm_b32 v214, v42, v38, s7
    v_perm_b32 v218, v42, v38, s8
    v_perm_b32 v222, v43, v39, s7
    v_perm_b32 v226, v43, v39, s8
    s_waitcnt vmcnt(9)
    v_sad_u8 v148, v148, 0, 0
    v_sad_u8 v148, v149, 0, v148
    v_sad_u8 v148, v150, 0, v148
    v_sad_u8 v148, v151, 0, v148
    s_mul_i32 s32, s79, 30
    v_readlane_b32 s30, v148, 0
    v_readlane_b32 s31, v148, 1
    s_add_u32 s30, s30, s31
    s_sub_u32 s30, s30, s32
    s_mul_i32 s30, s30, 205
    s_add_u32 s30, s30, 55312
    s_add_u32 s30, s30, s83
    s_ashr_i32 s30, s30, 13
    s_max_i32 s30, s30, 5
    s_min_i32 s72, s30, 8
    s_waitcnt vmcnt(11)
    s_cmp_ge_i32 s72, 8
    s_cbranch_scc1 L_deep62
    s_waitcnt vmcnt(8)
    s_cmp_ge_i32 s72, 7
    s_cbranch_scc1 L_deep62
    s_waitcnt vmcnt(7)
    s_cmp_ge_i32 s72, 6
    s_cbranch_scc1 L_deep62
    s_waitcnt vmcnt(6)
L_deep62:
    s_xor_b32 s30, s73, 13312
    buffer_load_dwordx4 v[76:79], v14, s[60:63], s30 offen nt
    s_waitcnt vmcnt(9)
    s_cmp_ge_i32 s72, 8
    s_cbranch_scc1 L_deep63
    s_waitcnt vmcnt(8)
    s_cmp_ge_i32 s72, 7
    s_cbranch_scc1 L_deep63
    s_waitcnt vmcnt(7)
    s_cmp_ge_i32 s72, 6
    s_cbranch_scc1 L_deep63
    s_waitcnt vmcnt(6)
L_deep63:
    s_xor_b32 s30, s73, 13824
    buffer_load_dwordx4 v[80:83], v14, s[60:63], s30 offen nt
    s_waitcnt vmcnt(10)
    v_perm_b32 v199, v48, v44, s7
    v_perm_b32 v203, v48, v44, s8
    v_perm_b32 v207, v49, v45, s7
    v_perm_b32 v211, v49, v45, s8
    v_perm_b32 v215, v50, v46, s7
    v_perm_b32 v219, v50, v46, s8
    v_perm_b32 v223, v51, v47, s7
    v_perm_b32 v227, v51, v47, s8
    s_waitcnt vmcnt(9)
    s_cmp_ge_i32 s72, 8
    s_cbranch_scc1 L_deep64
    s_waitcnt vmcnt(8)
    s_cmp_ge_i32 s72, 7
    s_cbranch_scc1 L_deep64
    s_waitcnt vmcnt(7)
    s_cmp_ge_i32 s72, 6
    s_cbranch_scc1 L_deep64
    s_waitcnt vmcnt(6)
L_deep64:
    s_xor_b32 s30, s73, 16384
    buffer_load_dwordx4 v[84:87], v14, s[60:63], s30 offen nt
    s_waitcnt vmcnt(9)
    s_cmp_ge_i32 s72, 8
    s_cbranch_scc1 L_deep65
    s_waitcnt vmcnt(8)
    s_cmp_ge_i32 s72, 7
    s_cbranch_scc1 L_deep65
    s_waitcnt vmcnt(7)
    s_cmp_ge_i32 s72, 6
    s_cbranch_scc1 L_deep65
    s_waitcnt vmcnt(4)
L_deep65:
    s_sub_u32 s79, 60, s72
    s_mov_b64 exec, 3
    v_mov_b32 v15, s79
    buffer_store_byte v15, off, s[84:87], s82
    buffer_load_dwordx4 v[148:151], v6, s[84:87], s81 offen nt
    s_mov_b64 exec, -1
    s_xor_b32 s30, s73, 16896
    buffer_load_dwordx4 v[88:91], v14, s[60:63], s30 offen nt
    s_waitcnt vmcnt(12)
    v_perm_b32 v20, v56, v52, s7
    v_perm_b32 v24, v56, v52, s8
    v_perm_b32 v28, v57, v53, s7
    v_perm_b32 v32, v57, v53, s8
    v_perm_b32 v36, v58, v54, s7
    v_perm_b32 v40, v58, v54, s8
    v_perm_b32 v44, v59, v55, s7
    v_perm_b32 v48, v59, v55, s8
    s_waitcnt vmcnt(11)
    s_cmp_ge_i32 s72, 8
    s_cbranch_scc1 L_deep66
    s_waitcnt vmcnt(10)
    s_cmp_ge_i32 s72, 7
    s_cbranch_scc1 L_deep66
    s_waitcnt vmcnt(7)
    s_cmp_ge_i32 s72, 6
    s_cbranch_scc1 L_deep66
    s_waitcnt vmcnt(6)
L_deep66:
    s_xor_b32 s30, s73, 17408
    buffer_load_dwordx4 v[92:95], v14, s[60:63], s30 offen nt
    s_waitcnt vmcnt(9)
    v_sad_u8 v152, v152, 0, 0
    v_sad_u8 v152, v153, 0, v152
    v_sad_u8 v152, v154, 0, v152
    v_sad_u8 v152, v155, 0, v152
    s_mul_i32 s32, s80, 30
    v_readlane_b32 s30, v152, 0
    v_readlane_b32 s31, v152, 1
    s_add_u32 s30, s30, s31
    s_sub_u32 s30, s30, s32
    s_mul_i32 s30, s30, 205
    s_add_u32 s30, s30, 55312
    s_add_u32 s30, s30, s83
    s_ashr_i32 s30, s30, 13
    s_max_i32 s30, s30, 5
    s_min_i32 s72, s30, 8
    s_waitcnt vmcnt(11)
    s_cmp_ge_i32 s72, 8
    s_cbranch_scc1 L_deep67
    s_waitcnt vmcnt(8)
    s_cmp_ge_i32 s72, 7
    s_cbranch_scc1 L_deep67
    s_waitcnt vmcnt(7)
    s_cmp_ge_i32 s72, 6
    s_cbranch_scc1 L_deep67
    s_waitcnt vmcnt(6)
L_deep67:
    s_xor_b32 s30, s73, 17920
    buffer_load_dwordx4 v[96:99], v14, s[60:63], s30 offen nt
    s_waitcnt vmcnt(12)
    v_perm_b32 v21, v64, v60, s7
    v_perm_b32 v25, v64, v60, s8
    v_perm_b32 v29, v65, v61, s7
    v_perm_b32 v33, v65, v61, s8
    v_perm_b32 v37, v66, v62, s7
    v_perm_b32 v41, v66, v62, s8
    v_perm_b32 v45, v67, v63, s7
    v_perm_b32 v49, v67, v63, s8
    s_barrier
    s_mov_b64 exec, s[34:35]
    ds_read_b128 v[164:167], v162 offset:0
    ds_read_b128 v[168:171], v162 offset:512
    ds_read_b128 v[172:175], v162 offset:1024
    ds_read_b128 v[176:179], v162 offset:1536
    s_not_b64 exec, exec
    ds_read_b128 v[180:183], v162 offset:0
    ds_read_b128 v[184:187], v162 offset:512
    ds_read_b128 v[188:191], v162 offset:1024
    ds_read_b128 v[192:195], v162 offset:1536
    s_mov_b64 exec, -1
    v_mov_b32 v5, 155008
    ds_read_b128 v[228:231], v5
    s_waitcnt vmcnt(9)
    s_cmp_ge_i32 s72, 8
    s_cbranch_scc1 L_deep68
    s_waitcnt vmcnt(8)
    s_cmp_ge_i32 s72, 7
    s_cbranch_scc1 L_deep68
    s_waitcnt vmcnt(7)
    s_cmp_ge_i32 s72, 6
    s_cbranch_scc1 L_deep68
    s_waitcnt vmcnt(6)
L_deep68:
    s_xor_b32 s30, s73, 20480
    buffer_load_dwordx4 v[100:103], v14, s[60:63], s30 offen nt
    s_waitcnt vmcnt(9)
    s_cmp_ge_i32 s72, 8
    s_cbranch_scc1 L_deep69
    s_waitcnt vmcnt(8)
    s_cmp_ge_i32 s72, 7
    s_cbranch_scc1 L_deep69
    s_waitcnt vmcnt(7)
    s_cmp_ge_i32 s72, 6
    s_cbranch_scc1 L_deep69
    s_waitcnt vmcnt(6)
L_deep69:
    s_xor_b32 s30, s73, 20992
    buffer_load_dwordx4 v[104:107], v14, s[60:63], s30 offen nt
    s_waitcnt vmcnt(10)
    v_perm_b32 v22, v72, v68, s7
    v_perm_b32 v26, v72, v68, s8
    v_perm_b32 v30, v73, v69, s7
    v_perm_b32 v34, v73, v69, s8
    v_perm_b32 v38, v74, v70, s7
    v_perm_b32 v42, v74, v70, s8
    v_perm_b32 v46, v75, v71, s7
    v_perm_b32 v50, v75, v71, s8
    s_waitcnt lgkmcnt(0)
    v_or3_b32 v5, v228, v229, v230
    v_or_b32 v5, v5, v231
    s_nop 0
    v_readfirstlane_b32 s51, v5
    s_xor_b32 s52, s51, 268435456
    v_mfma_f32_16x16x32_bf16 v[228:231], v[196:199], v[164:167], 0
    v_mfma_f32_16x16x32_bf16 v[232:235], v[200:203], v[164:167], 0
    v_mfma_f32_16x16x32_bf16 v[236:239], v[204:207], v[164:167], 0
    v_mfma_f32_16x16x32_bf16 v[240:243], v[208:211], v[164:167], 0
    v_mfma_f32_16x16x32_bf16 v[228:231], v[212:215], v[180:183], v[228:231]
    v_mfma_f32_16x16x32_bf16 v[232:235], v[216:219], v[180:183], v[232:235]
    v_mfma_f32_16x16x32_bf16 v[236:239], v[220:223], v[180:183], v[236:239]
    v_mfma_f32_16x16x32_bf16 v[240:243], v[224:227], v[180:183], v[240:243]
    s_waitcnt vmcnt(9)
    s_cmp_ge_i32 s72, 8
    s_cbranch_scc1 L_deep70
    s_waitcnt vmcnt(8)
    s_cmp_ge_i32 s72, 7
    s_cbranch_scc1 L_deep70
    s_waitcnt vmcnt(7)
    s_cmp_ge_i32 s72, 6
    s_cbranch_scc1 L_deep70
    s_waitcnt vmcnt(4)
L_deep70:
    s_sub_u32 s80, 65, s72
    s_mov_b64 exec, 3
    v_mov_b32 v15, s80
    buffer_store_byte v15, off, s[84:87], s82
    buffer_load_dwordx4 v[152:155], v6, s[84:87], s81 offen nt
    s_mov_b64 exec, -1
    s_xor_b32 s30, s73, 21504
    buffer_load_dwordx4 v[108:111], v14, s[60:63], s30 offen nt
    s_waitcnt vmcnt(11)
    s_cmp_ge_i32 s72, 8
    s_cbranch_scc1 L_deep71
    s_waitcnt vmcnt(10)
    s_cmp_ge_i32 s72, 7
    s_cbranch_scc1 L_deep71
    s_waitcnt vmcnt(7)
    s_cmp_ge_i32 s72, 6
    s_cbranch_scc1 L_deep71
    s_waitcnt vmcnt(6)
L_deep71:
    s_xor_b32 s30, s73, 22016
    buffer_load_dwordx4 v[112:115], v14, s[60:63], s30 offen nt
    s_waitcnt vmcnt(12)
    v_perm_b32 v23, v80, v76, s7
    v_perm_b32 v27, v80, v76, s8
    v_perm_b32 v31, v81, v77, s7
    v_perm_b32 v35, v81, v77, s8
    v_perm_b32 v39, v82, v78, s7
    v_perm_b32 v43, v82, v78, s8
    v_perm_b32 v47, v83, v79, s7
    v_perm_b32 v51, v83, v79, s8
    v_mfma_f32_16x16x32_bf16 v[228:231], v[20:23], v[168:171], v[228:231]
    v_mfma_f32_16x16x32_bf16 v[232:235], v[24:27], v[168:171], v[232:235]
    v_mfma_f32_16x16x32_bf16 v[236:239], v[28:31], v[168:171], v[236:239]
    v_mfma_f32_16x16x32_bf16 v[240:243], v[32:35], v[168:171], v[240:243]
    v_mfma_f32_16x16x32_bf16 v[228:231], v[36:39], v[184:187], v[228:231]
    v_mfma_f32_16x16x32_bf16 v[232:235], v[40:43], v[184:187], v[232:235]
    v_mfma_f32_16x16x32_bf16 v[236:239], v[44:47], v[184:187], v[236:239]
    v_mfma_f32_16x16x32_bf16 v[240:243], v[48:51], v[184:187], v[240:243]
    s_waitcnt vmcnt(9)
    v_sad_u8 v148, v148, 0, 0
    v_sad_u8 v148, v149, 0, v148
    v_sad_u8 v148, v150, 0, v148
    v_sad_u8 v148, v151, 0, v148
    s_mul_i32 s32, s79, 30
    v_readlane_b32 s30, v148, 0
    v_readlane_b32 s31, v148, 1
    s_add_u32 s30, s30, s31
    s_sub_u32 s30, s30, s32
    s_mul_i32 s30, s30, 205
    s_add_u32 s30, s30, 55312
    s_add_u32 s30, s30, s83
    s_ashr_i32 s30, s30, 13
    s_max_i32 s30, s30, 5
    s_min_i32 s72, s30, 8
    s_waitcnt vmcnt(11)
    s_cmp_ge_i32 s72, 8
    s_cbranch_scc1 L_deep72
    s_waitcnt vmcnt(8)
    s_cmp_ge_i32 s72, 7
    s_cbranch_scc1 L_deep72
    s_waitcnt vmcnt(7)
    s_cmp_ge_i32 s72, 6
    s_cbranch_scc1 L_deep72
    s_waitcnt vmcnt(6)
L_deep72:
    s_xor_b32 s30, s73, 24576
    buffer_load_dwordx4 v[116:119], v14, s[60:63], s30 offen nt
    s_waitcnt vmcnt(9)
    s_cmp_ge_i32 s72, 8
    s_cbranch_scc1 L_deep73
    s_waitcnt vmcnt(8)
    s_cmp_ge_i32 s72, 7
    s_cbranch_scc1 L_deep73
    s_waitcnt vmcnt(7)
    s_cmp_ge_i32 s72, 6
    s_cbranch_scc1 L_deep73
    s_waitcnt vmcnt(6)
L_deep73:
    s_xor_b32 s30, s73, 25088
    buffer_load_dwordx4 v[120:123], v14, s[60:63], s30 offen nt
    s_waitcnt vmcnt(10)
    v_perm_b32 v52, v88, v84, s7
    v_perm_b32 v56, v88, v84, s8
    v_perm_b32 v60, v89, v85, s7
    v_perm_b32 v64, v89, v85, s8
    v_perm_b32 v68, v90, v86, s7
    v_perm_b32 v72, v90, v86, s8
    v_perm_b32 v76, v91, v87, s7
    v_perm_b32 v80, v91, v87, s8
    s_waitcnt vmcnt(9)
    s_cmp_ge_i32 s72, 8
    s_cbranch_scc1 L_deep74
    s_waitcnt vmcnt(8)
    s_cmp_ge_i32 s72, 7
    s_cbranch_scc1 L_deep74
    s_waitcnt vmcnt(7)
    s_cmp_ge_i32 s72, 6
    s_cbranch_scc1 L_deep74
    s_waitcnt vmcnt(6)
L_deep74:
    s_xor_b32 s30, s73, 25600
    buffer_load_dwordx4 v[124:127], v14, s[60:63], s30 offen nt
    s_waitcnt vmcnt(9)
    s_cmp_ge_i32 s72, 8
    s_cbranch_scc1 L_deep75
    s_waitcnt vmcnt(8)
    s_cmp_ge_i32 s72, 7
    s_cbranch_scc1 L_deep75
    s_waitcnt vmcnt(7)
    s_cmp_ge_i32 s72, 6
    s_cbranch_scc1 L_deep75
    s_waitcnt vmcnt(4)
L_deep75:
    s_sub_u32 s79, 70, s72
    s_mov_b64 exec, 3
    v_mov_b32 v15, s79
    buffer_store_byte v15, off, s[84:87], s82
    buffer_load_dwordx4 v[148:151], v6, s[84:87], s81 offen nt
    s_mov_b64 exec, -1
    s_xor_b32 s30, s73, 26112
    buffer_load_dwordx4 v[128:131], v14, s[60:63], s30 offen nt
    s_waitcnt vmcnt(12)
    v_perm_b32 v53, v96, v92, s7
    v_perm_b32 v57, v96, v92, s8
    v_perm_b32 v61, v97, v93, s7
    v_perm_b32 v65, v97, v93, s8
    v_perm_b32 v69, v98, v94, s7
    v_perm_b32 v73, v98, v94, s8
    v_perm_b32 v77, v99, v95, s7
    v_perm_b32 v81, v99, v95, s8
    s_waitcnt vmcnt(11)
    s_cmp_ge_i32 s72, 8
    s_cbranch_scc1 L_deep76
    s_waitcnt vmcnt(10)
    s_cmp_ge_i32 s72, 7
    s_cbranch_scc1 L_deep76
    s_waitcnt vmcnt(7)
    s_cmp_ge_i32 s72, 6
    s_cbranch_scc1 L_deep76
    s_waitcnt vmcnt(6)
L_deep76:
    s_xor_b32 s30, s73, 28672
    buffer_load_dwordx4 v[132:135], v14, s[60:63], s30 offen nt
    s_branch L_pb_l2
    .p2align 12
L_pad_l2:
    s_branch L_ret_l2
L_pb_l2:
    s_waitcnt vmcnt(9)
    v_sad_u8 v152, v152, 0, 0
    v_sad_u8 v152, v153, 0, v152
    v_sad_u8 v152, v154, 0, v152
    v_sad_u8 v152, v155, 0, v152
    s_mul_i32 s32, s80, 30
    v_readlane_b32 s30, v152, 0
    v_readlane_b32 s31, v152, 1
    s_add_u32 s30, s30, s31
    s_sub_u32 s30, s30, s32
    s_mul_i32 s30, s30, 205
    s_add_u32 s30, s30, 55312
    s_add_u32 s30, s30, s83
    s_ashr_i32 s30, s30, 13
    s_max_i32 s30, s30, 5
    s_min_i32 s72, s30, 8
    s_waitcnt vmcnt(11)
    s_cmp_ge_i32 s72, 8
    s_cbranch_scc1 L_deep77
    s_waitcnt vmcnt(8)
    s_cmp_ge_i32 s72, 7
    s_cbranch_scc1 L_deep77
    s_waitcnt vmcnt(7)
    s_cmp_ge_i32 s72, 6
    s_cbranch_scc1 L_deep77
    s_waitcnt vmcnt(6)
L_deep77:
    s_xor_b32 s30, s73, 29184
    buffer_load_dwordx4 v[136:139], v14, s[60:63], s30 offen nt
    s_waitcnt vmcnt(12)
    v_perm_b32 v54, v104, v100, s7
    v_perm_b32 v58, v104, v100, s8
    v_perm_b32 v62, v105, v101, s7
    v_perm_b32 v66, v105, v101, s8
    v_perm_b32 v70, v106, v102, s7
    v_perm_b32 v74, v106, v102, s8
    v_perm_b32 v78, v107, v103, s7
    v_perm_b32 v82, v107, v103, s8
    s_waitcnt vmcnt(9)
    s_cmp_ge_i32 s72, 8
    s_cbranch_scc1 L_deep78
    s_waitcnt vmcnt(8)
    s_cmp_ge_i32 s72, 7
    s_cbranch_scc1 L_deep78
    s_waitcnt vmcnt(7)
    s_cmp_ge_i32 s72, 6
    s_cbranch_scc1 L_deep78
    s_waitcnt vmcnt(6)
L_deep78:
    s_xor_b32 s30, s73, 29696
    buffer_load_dwordx4 v[140:143], v14, s[60:63], s30 offen nt
    s_waitcnt vmcnt(9)
    s_cmp_ge_i32 s72, 8
    s_cbranch_scc1 L_deep79
    s_waitcnt vmcnt(8)
    s_cmp_ge_i32 s72, 7
    s_cbranch_scc1 L_deep79
    s_waitcnt vmcnt(7)
    s_cmp_ge_i32 s72, 6
    s_cbranch_scc1 L_deep79
    s_waitcnt vmcnt(6)
L_deep79:
    s_xor_b32 s30, s73, 30208
    buffer_load_dwordx4 v[144:147], v14, s[60:63], s30 offen nt
    s_waitcnt vmcnt(10)
    v_perm_b32 v55, v112, v108, s7
    v_perm_b32 v59, v112, v108, s8
    v_perm_b32 v63, v113, v109, s7
    v_perm_b32 v67, v113, v109, s8
    v_perm_b32 v71, v114, v110, s7
    v_perm_b32 v75, v114, v110, s8
    v_perm_b32 v79, v115, v111, s7
    v_perm_b32 v83, v115, v111, s8
    v_mfma_f32_16x16x32_bf16 v[228:231], v[52:55], v[172:175], v[228:231]
    v_mfma_f32_16x16x32_bf16 v[232:235], v[56:59], v[172:175], v[232:235]
    v_mfma_f32_16x16x32_bf16 v[236:239], v[60:63], v[172:175], v[236:239]
    v_mfma_f32_16x16x32_bf16 v[240:243], v[64:67], v[172:175], v[240:243]
    v_mfma_f32_16x16x32_bf16 v[228:231], v[68:71], v[188:191], v[228:231]
    v_mfma_f32_16x16x32_bf16 v[232:235], v[72:75], v[188:191], v[232:235]
    v_mfma_f32_16x16x32_bf16 v[236:239], v[76:79], v[188:191], v[236:239]
    v_mfma_f32_16x16x32_bf16 v[240:243], v[80:83], v[188:191], v[240:243]
    s_waitcnt vmcnt(9)
    s_cmp_ge_i32 s72, 8
    s_cbranch_scc1 L_deep80
    s_waitcnt vmcnt(8)
    s_cmp_ge_i32 s72, 7
    s_cbranch_scc1 L_deep80
    s_waitcnt vmcnt(7)
    s_cmp_ge_i32 s72, 6
    s_cbranch_scc1 L_deep80
    s_waitcnt vmcnt(4)
L_deep80:
    s_sub_u32 s80, 75, s72
    s_mov_b64 exec, 3
    v_mov_b32 v15, s80
    buffer_store_byte v15, off, s[84:87], s82
    buffer_load_dwordx4 v[152:155], v6, s[84:87], s81 offen nt
    s_mov_b64 exec, -1
    s_add_u32 m0, s78, 0
    s_add_u32 s30, s75, s4
    buffer_load_dwordx4 v11, s[68:71], s30 offen nt lds
    s_add_u32 s4, s4, s5
    s_and_b32 s4, s4, s6
    s_add_u32 s75, s75, s76
    s_waitcnt vmcnt(11)
    v_perm_b32 v84, v120, v116, s7
    v_perm_b32 v88, v120, v116, s8
    v_perm_b32 v92, v121, v117, s7
    v_perm_b32 v96, v121, v117, s8
    v_perm_b32 v100, v122, v118, s7
    v_perm_b32 v104, v122, v118, s8
    v_perm_b32 v108, v123, v119, s7
    v_perm_b32 v112, v123, v119, s8
    s_waitcnt vmcnt(7)
    v_perm_b32 v85, v128, v124, s7
    v_perm_b32 v89, v128, v124, s8
    v_perm_b32 v93, v129, v125, s7
    v_perm_b32 v97, v129, v125, s8
    v_perm_b32 v101, v130, v126, s7
    v_perm_b32 v105, v130, v126, s8
    v_perm_b32 v109, v131, v127, s7
    v_perm_b32 v113, v131, v127, s8
    s_waitcnt vmcnt(6)
    s_add_u32 m0, s78, 4096
    s_add_u32 s30, s75, s4
    buffer_load_dwordx4 v11, s[68:71], s30 offen nt lds
    s_add_u32 s4, s4, s5
    s_and_b32 s4, s4, s6
    s_add_u32 s75, s75, s76
    s_waitcnt vmcnt(9)
    v_sad_u8 v148, v148, 0, 0
    v_sad_u8 v148, v149, 0, v148
    v_sad_u8 v148, v150, 0, v148
    v_sad_u8 v148, v151, 0, v148
    s_mul_i32 s32, s79, 30
    v_readlane_b32 s30, v148, 0
    v_readlane_b32 s31, v148, 1
    s_add_u32 s30, s30, s31
    s_sub_u32 s30, s30, s32
    s_mul_i32 s30, s30, 205
    s_add_u32 s30, s30, 55312
    s_add_u32 s30, s30, s83
    s_ashr_i32 s30, s30, 13
    s_max_i32 s30, s30, 5
    s_min_i32 s72, s30, 8
    s_waitcnt vmcnt(6)
    s_add_u32 m0, s78, 8192
    s_add_u32 s30, s75, s4
    buffer_load_dwordx4 v11, s[68:71], s30 offen nt lds
    s_add_u32 s4, s4, s5
    s_and_b32 s4, s4, s6
    s_add_u32 s75, s75, s76
    s_waitcnt vmcnt(7)
    v_perm_b32 v86, v136, v132, s7
    v_perm_b32 v90, v136, v132, s8
    v_perm_b32 v94, v137, v133, s7
    v_perm_b32 v98, v137, v133, s8
    v_perm_b32 v102, v138, v134, s7
    v_perm_b32 v106, v138, v134, s8
    v_perm_b32 v110, v139, v135, s7
    v_perm_b32 v114, v139, v135, s8
    s_waitcnt vmcnt(6)
    s_add_u32 m0, s78, 12288
    s_add_u32 s30, s75, s4
    buffer_load_dwordx4 v11, s[68:71], s30 offen nt lds
    s_add_u32 s4, s4, s5
    s_and_b32 s4, s4, s6
    s_add_u32 s75, s75, s76
    s_waitcnt vmcnt(6)
    v_perm_b32 v87, v144, v140, s7
    v_perm_b32 v91, v144, v140, s8
    v_perm_b32 v95, v145, v141, s7
    v_perm_b32 v99, v145, v141, s8
    v_perm_b32 v103, v146, v142, s7
    v_perm_b32 v107, v146, v142, s8
    v_perm_b32 v111, v147, v143, s7
    v_perm_b32 v115, v147, v143, s8
    v_mfma_f32_16x16x32_bf16 v[228:231], v[84:87], v[176:179], v[228:231]
    v_mfma_f32_16x16x32_bf16 v[232:235], v[88:91], v[176:179], v[232:235]
    v_mfma_f32_16x16x32_bf16 v[236:239], v[92:95], v[176:179], v[236:239]
    v_mfma_f32_16x16x32_bf16 v[240:243], v[96:99], v[176:179], v[240:243]
    v_mfma_f32_16x16x32_bf16 v[228:231], v[100:103], v[192:195], v[228:231]
    v_mfma_f32_16x16x32_bf16 v[232:235], v[104:107], v[192:195], v[232:235]
    v_mfma_f32_16x16x32_bf16 v[236:239], v[108:111], v[192:195], v[236:239]
    v_mfma_f32_16x16x32_bf16 v[240:243], v[112:115], v[192:195], v[240:243]
    s_nop 4
    ds_write_b128 v159, v[228:231] offset:0
    ds_write_b128 v159, v[232:235] offset:576
    ds_write_b128 v159, v[236:239] offset:1152
    ds_write_b128 v159, v[240:243] offset:1728
    s_waitcnt lgkmcnt(0)
    s_cmp_ge_u32 s2, 240
    s_barrier
    s_cbranch_scc1 L_redl
    s_barrier
    s_cmp_lt_u32 s2, 128
    s_cselect_b32 s30, 2, 1
    s_add_u32 s72, s72, s30
    s_lshl_b32 s83, s30, 13
    s_waitcnt vmcnt(6)
    s_add_u32 m0, s78, 16384
    s_add_u32 s30, s75, s4
    buffer_load_dwordx4 v11, s[68:71], s30 offen nt lds
    s_add_u32 s4, s4, s5
    s_and_b32 s4, s4, s6
    s_add_u32 s75, s75, s76
    s_waitcnt vmcnt(7)
    s_cmp_ge_i32 s72, 6
    s_cbranch_scc1 L_deep85
    s_waitcnt vmcnt(4)
L_deep85:
    s_add_u32 m0, s78, 20480
    s_add_u32 s30, s75, s4
    buffer_load_dwordx4 v11, s[68:71], s30 offen nt lds
    s_add_u32 s4, s4, s5
    s_and_b32 s4, s4, s6
    s_add_u32 s75, s75, s76
    s_waitcnt vmcnt(8)
    s_cmp_ge_i32 s72, 7
    s_cbranch_scc1 L_deep86
    s_waitcnt vmcnt(5)
    s_cmp_ge_i32 s72, 6
    s_cbranch_scc1 L_deep86
    s_waitcnt vmcnt(4)
L_deep86:
    s_add_u32 m0, s78, 24576
    s_add_u32 s30, s75, s4
    buffer_load_dwordx4 v11, s[68:71], s30 offen nt lds
    s_add_u32 s4, s4, s5
    s_and_b32 s4, s4, s6
    s_add_u32 s75, s75, s76
    s_cmp_lt_u32 s2, 128
    s_cbranch_scc1 L_al
    ds_read_b128 v[52:55], v156 offset:0
    ds_read_b128 v[56:59], v156 offset:64
    ds_read_b128 v[60:63], v156 offset:128
    ds_read_b128 v[64:67], v156 offset:192
L_al:
    s_waitcnt vmcnt(7)
    v_sad_u8 v152, v152, 0, 0
    v_sad_u8 v152, v153, 0, v152
    v_sad_u8 v152, v154, 0, v152
    v_sad_u8 v152, v155, 0, v152
    s_mul_i32 s32, s80, 30
    v_readlane_b32 s30, v152, 0
    v_readlane_b32 s31, v152, 1
    s_add_u32 s30, s30, s31
    s_sub_u32 s30, s30, s32
    s_mul_i32 s30, s30, 205
    s_add_u32 s30, s30, 55312
    s_add_u32 s30, s30, s83
    s_ashr_i32 s30, s30, 13
    s_max_i32 s30, s30, 5
    s_min_i32 s72, s30, 8
    s_waitcnt vmcnt(9)
    s_cmp_ge_i32 s72, 8
    s_cbranch_scc1 L_deep87
    s_waitcnt vmcnt(6)
    s_cmp_ge_i32 s72, 7
    s_cbranch_scc1 L_deep87
    s_waitcnt vmcnt(5)
    s_cmp_ge_i32 s72, 6
    s_cbranch_scc1 L_deep87
    s_waitcnt vmcnt(4)
L_deep87:
    s_add_u32 m0, s78, 28672
    s_add_u32 s30, s75, s4
    buffer_load_dwordx4 v11, s[68:71], s30 offen nt lds
    s_add_u32 s4, s4, s5
    s_and_b32 s4, s4, s6
    s_add_u32 s75, s75, s77
    s_waitcnt vmcnt(7)
    s_cmp_ge_i32 s72, 8
    s_cbranch_scc1 L_deep88
    s_waitcnt vmcnt(6)
    s_cmp_ge_i32 s72, 7
    s_cbranch_scc1 L_deep88
    s_waitcnt vmcnt(5)
    s_cmp_ge_i32 s72, 6
    s_cbranch_scc1 L_deep88
    s_waitcnt vmcnt(4)
L_deep88:
    s_add_u32 m0, s78, 32768
    s_add_u32 s30, s75, s4
    buffer_load_dwordx4 v11, s[68:71], s30 offen nt lds
    s_add_u32 s4, s4, s5
    s_and_b32 s4, s4, s6
    s_add_u32 s75, s75, s76
    s_waitcnt vmcnt(7)
    s_cmp_ge_i32 s72, 8
    s_cbranch_scc1 L_deep89
    s_waitcnt vmcnt(6)
    s_cmp_ge_i32 s72, 7
    s_cbranch_scc1 L_deep89
    s_waitcnt vmcnt(5)
    s_cmp_ge_i32 s72, 6
    s_cbranch_scc1 L_deep89
    s_waitcnt vmcnt(4)
L_deep89:
    s_add_u32 m0, s78, 36864
    s_add_u32 s30, s75, s4
    buffer_load_dwordx4 v11, s[68:71], s30 offen nt lds
    s_add_u32 s4, s4, s5
    s_and_b32 s4, s4, s6
    s_add_u32 s75, s75, s76
    s_waitcnt vmcnt(7)
    s_cmp_ge_i32 s72, 8
    s_cbranch_scc1 L_deep90
    s_waitcnt vmcnt(6)
    s_cmp_ge_i32 s72, 7
    s_cbranch_scc1 L_deep90
    s_waitcnt vmcnt(5)
    s_cmp_ge_i32 s72, 6
    s_cbranch_scc1 L_deep90
    s_waitcnt vmcnt(4)
L_deep90:
    s_add_u32 m0, s78, 40960
    s_add_u32 s30, s75, s4
    buffer_load_dwordx4 v11, s[68:71], s30 offen nt lds
    s_add_u32 s4, s4, s5
    s_and_b32 s4, s4, s6
    s_add_u32 s75, s75, s76
    s_waitcnt vmcnt(7)
    s_cmp_ge_i32 s72, 8
    s_cbranch_scc1 L_deep91
    s_waitcnt vmcnt(6)
    s_cmp_ge_i32 s72, 7
    s_cbranch_scc1 L_deep91
    s_waitcnt vmcnt(5)
    s_cmp_ge_i32 s72, 6
    s_cbranch_scc1 L_deep91
    s_waitcnt vmcnt(4)
L_deep91:
    s_add_u32 m0, s78, 45056
    s_add_u32 s30, s75, s4
    buffer_load_dwordx4 v11, s[68:71], s30 offen nt lds
    s_add_u32 s4, s4, s5
    s_and_b32 s4, s4, s6
    s_add_u32 s75, s75, s76
    s_waitcnt vmcnt(7)
    s_cmp_ge_i32 s72, 8
    s_cbranch_scc1 L_deep92
    s_waitcnt vmcnt(6)
    s_cmp_ge_i32 s72, 7
    s_cbranch_scc1 L_deep92
    s_waitcnt vmcnt(5)
    s_cmp_ge_i32 s72, 6
    s_cbranch_scc1 L_deep92
    s_waitcnt vmcnt(4)
L_deep92:
    s_add_u32 m0, s78, 49152
    s_add_u32 s30, s75, s4
    buffer_load_dwordx4 v11, s[68:71], s30 offen nt lds
    s_add_u32 s4, s4, s5
    s_and_b32 s4, s4, s6
    s_add_u32 s75, s75, s76
    s_waitcnt vmcnt(7)
    s_cmp_ge_i32 s72, 8
    s_cbranch_scc1 L_deep93
    s_waitcnt vmcnt(6)
    s_cmp_ge_i32 s72, 7
    s_cbranch_scc1 L_deep93
    s_waitcnt vmcnt(5)
    s_cmp_ge_i32 s72, 6
    s_cbranch_scc1 L_deep93
    s_waitcnt vmcnt(4)
L_deep93:
    s_add_u32 m0, s78, 53248
    s_add_u32 s30, s75, s4
    buffer_load_dwordx4 v11, s[68:71], s30 offen nt lds
    s_add_u32 s4, s4, s5
    s_and_b32 s4, s4, s6
    s_add_u32 s75, s75, s76
    s_waitcnt vmcnt(8)
    s_barrier
    s_add_u32 m0, s78, 57344
    s_add_u32 s30, s75, s4
    buffer_load_dwordx4 v11, s[68:71], s30 offen nt lds
    s_add_u32 s4, s4, s5
    s_and_b32 s4, s4, s6
    s_add_u32 s75, s75, s76
    s_add_u32 m0, s78, 61440
    s_add_u32 s30, s75, s4
    buffer_load_dwordx4 v11, s[68:71], s30 offen nt lds
    s_cmp_lt_u32 s2, 128
    ds_read_b64_tr_b16 v[20:21], v157 offset:0
    ds_read_b64_tr_b16 v[22:23], v157 offset:1024
    ds_read_b64_tr_b16 v[24:25], v157 offset:8192
    ds_read_b64_tr_b16 v[26:27], v157 offset:9216
    ds_read_b64_tr_b16 v[28:29], v157 offset:16384
    ds_read_b64_tr_b16 v[30:31], v157 offset:17408
    s_cbranch_scc1 L_yl
    s_waitcnt lgkmcnt(0)
    v_mfma_f32_16x16x32_bf16 v[84:87], v[20:23], v[52:55], 0
    v_mfma_f32_16x16x32_bf16 v[84:87], v[24:27], v[56:59], v[84:87]
    v_mfma_f32_16x16x32_bf16 v[84:87], v[28:31], v[60:63], v[84:87]
L_yl:
    s_waitcnt vmcnt(4)
    s_barrier
    ds_read_b64_tr_b16 v[32:33], v157 offset:24576
    ds_read_b64_tr_b16 v[34:35], v157 offset:25600
    ds_read_b64_tr_b16 v[36:37], v157 offset:32768
    ds_read_b64_tr_b16 v[38:39], v157 offset:33792
    ds_read_b64_tr_b16 v[40:41], v157 offset:40960
    ds_read_b64_tr_b16 v[42:43], v157 offset:41984
    s_cmp_lt_u32 s2, 128
    s_cbranch_scc1 L_noearly
    s_waitcnt lgkmcnt(0)
    v_mfma_f32_16x16x32_bf16 v[88:91], v[36:39], v[52:55], 0
    v_mfma_f32_16x16x32_bf16 v[88:91], v[40:43], v[56:59], v[88:91]
    v_mfma_f32_16x16x32_bf16 v[84:87], v[32:35], v[64:67], v[84:87]
L_noearly:
    s_waitcnt vmcnt(0) lgkmcnt(0)
    s_barrier
    s_cbranch_scc1 L_lwl
    ds_read_b64_tr_b16 v[44:45], v157 offset:49152
    ds_read_b64_tr_b16 v[46:47], v157 offset:50176
    ds_read_b64_tr_b16 v[48:49], v157 offset:57344
    ds_read_b64_tr_b16 v[50:51], v157 offset:58368
    s_branch L_lxl
L_lwl:
    ds_read_b128 v[52:55], v156 offset:0
    ds_read_b128 v[56:59], v156 offset:64
    ds_read_b128 v[60:63], v156 offset:128
    ds_read_b128 v[64:67], v156 offset:192
    ds_read_b64_tr_b16 v[44:45], v157 offset:49152
    ds_read_b64_tr_b16 v[46:47], v157 offset:50176
    ds_read_b64_tr_b16 v[48:49], v157 offset:57344
    ds_read_b64_tr_b16 v[50:51], v157 offset:58368
    s_waitcnt lgkmcnt(7)
    v_mfma_f32_16x16x32_bf16 v[84:87], v[20:23], v[52:55], 0
    v_mfma_f32_16x16x32_bf16 v[88:91], v[36:39], v[52:55], 0
    s_waitcnt lgkmcnt(6)
    v_mfma_f32_16x16x32_bf16 v[84:87], v[24:27], v[56:59], v[84:87]
    v_mfma_f32_16x16x32_bf16 v[88:91], v[40:43], v[56:59], v[88:91]
    s_waitcnt lgkmcnt(5)
    v_mfma_f32_16x16x32_bf16 v[84:87], v[28:31], v[60:63], v[84:87]
    s_waitcnt lgkmcnt(4)
    v_mfma_f32_16x16x32_bf16 v[84:87], v[32:35], v[64:67], v[84:87]
L_lxl:
    s_waitcnt lgkmcnt(2)
    v_mfma_f32_16x16x32_bf16 v[88:91], v[44:47], v[60:63], v[88:91]
    s_waitcnt lgkmcnt(0)
    v_mfma_f32_16x16x32_bf16 v[88:91], v[48:51], v[64:67], v[88:91]
    s_nop 7
    v_add_f32_dpp v84, v88, v84 row_ror:8 row_mask:0xf bank_mask:0x3
    v_add_f32_dpp v85, v89, v85 row_ror:8 row_mask:0xf bank_mask:0x3
    s_cmp_eq_u32 s51, 0
    v_add_f32_dpp v84, v86, v90 row_ror:8 row_mask:0xf bank_mask:0xc
    v_add_f32_dpp v85, v87, v91 row_ror:8 row_mask:0xf bank_mask:0xc
    v_bfi_b32 v84, v9, v160, v84
    v_bfi_b32 v85, v9, v161, v85
    buffer_store_dwordx2 v[84:85], v158, s[36:39], s51 offen
    s_cbranch_scc1 L_pubfl
    buffer_store_dwordx2 v[84:85], v158, s[36:39], s52 offen sc1
L_pubfl:
L_finl:
    s_endpgm
    .p2align 12
L_compute:
    s_sub_u32 s53, s3, 4
    v_lshrrev_b32 v2, 5, v1
    v_and_b32 v3, 31, v1
    v_lshlrev_b32 v3, 4, v3
    v_lshl_add_u32 v11, v2, 11, v3
    s_lshl_b32 s31, s53, 12
    s_lshl_b32 s32, s47, 10
    s_add_u32 s54, s31, s32
    s_xor_b32 s55, s54, 1024
    s_mul_i32 s30, s53, 2112
    s_add_u32 s30, s30, 131072
    v_mul_u32_u24 v2, 1056, v2
    v_add3_u32 v12, v2, v3, s30
    s_waitcnt lgkmcnt(0)
    s_load_dword s33, s[28:29], 0x90000
    s_mov_b32 s56, s4
    s_and_b32 s57, s5, 0xffff
    s_mov_b32 s58, 16384
    s_mov_b32 s59, 0x20000
    s_cmp_ge_u32 s2, 240
    s_cbranch_scc1 L_nx
    buffer_load_dwordx4 v[16:19], v11, s[56:59], s54 offen offset:0
    buffer_load_dwordx4 v[20:23], v11, s[56:59], s54 offen offset:512
    buffer_load_dwordx4 v[24:27], v11, s[56:59], s55 offen offset:0
    buffer_load_dwordx4 v[28:31], v11, s[56:59], s55 offen offset:512
L_nx:
    s_mov_b32 s60, s18
    s_and_b32 s61, s19, 0xffff
    s_mov_b32 s62, 7168
    s_mov_b32 s63, 0x20000
    s_mov_b32 s64, s22
    s_and_b32 s65, s23, 0xffff
    s_mov_b32 s66, 2048
    s_mov_b32 s67, 0x20000
    s_mov_b32 s68, s24
    s_and_b32 s69, s25, 0xffff
    s_mov_b32 s70, 16384
    s_mov_b32 s71, 0x20000
    s_mov_b32 s36, s28
    s_and_b32 s37, s29, 0xffff
    s_mov_b32 s38, 8388608
    s_mov_b32 s39, 0x20000
    s_lshr_b32 s44, s2, 3
    s_and_b32 s45, s2, 7
    s_mov_b32 s34, 0x00ff00ff
    s_mov_b32 s35, 0x00ff00ff
    v_lshrrev_b32 v7, 4, v1
    v_and_b32 v8, 7, v1
    v_mov_b32 v9, 0xff
    v_mov_b32 v10, 0
    s_bfe_u32 s4, s2, 0x30002
    s_and_b32 s5, s2, 3
    s_lshr_b32 s6, s2, 5
    s_lshl_b32 s30, s45, 5
    s_add_u32 s30, s30, s44
    s_lshl_b32 s30, s30, 12
    s_add_u32 s7, s30, 2097152
    s_getreg_b32 s8, hwreg(HW_REG_XCC_ID, 0, 4)
    s_mov_b32 s9, 0x07060302
    v_and_b32 v14, 255, v0
    v_lshrrev_b32 v15, 5, v14
    v_and_b32 v36, 31, v14
    s_lshr_b32 s30, s44, 2
    s_lshl_b32 s30, s30, 5
    s_lshl_b32 s31, s45, 8
    s_add_u32 s30, s30, s31
    s_mul_i32 s31, s53, 2
    s_and_b32 s31, s31, 7
    v_and_b32 v40, 1, v1
    v_or_b32 v40, s31, v40
    v_and_b32 v2, 3, v40
    v_lshl_add_u32 v2, v2, 2, v7
    v_lshl_add_u32 v2, v2, 1, s30
    s_and_b32 s31, s44, 3
    s_lshl_b32 s31, s31, 12
    v_lshrrev_b32 v3, 2, v40
    v_lshl_add_u32 v3, v3, 11, s31
    v_add_u32 v37, v2, v3
    s_lshl_b32 s30, s5, 15
    s_and_b32 s31, s4, 1
    s_lshl_b32 s31, s31, 8
    s_add_u32 s30, s30, s31
    s_lshr_b32 s31, s4, 1
    s_lshl_b32 s31, s31, 6
    s_add_u32 s11, s30, s31
    v_lshrrev_b32 v3, 2, v14
    v_lshlrev_b32 v3, 9, v3
    v_and_b32 v4, 3, v14
    v_lshl_add_u32 v41, v4, 4, v3
    s_lshl_b32 s30, s44, 12
    s_add_u32 s12, s30, 65536
    v_lshlrev_b32 v42, 4, v14
    v_and_b32 v3, 6, v15
    v_add_u32 v3, v3, v15
    s_mul_i32 s30, s44, 1
    v_subrev_u32 v3, s30, v3
    v_bfe_u32 v2, v14, 2, 2
    v_bfe_u32 v5, v14, 4, 1
    v_lshl_add_u32 v2, v2, 1, v5
    v_and_or_b32 v5, v3, 8, v2
    v_mul_u32_u24 v5, 288, v5
    v_lshl_add_u32 v5, v4, 3, v5
    v_and_b32 v44, 7, v3
    v_lshl_add_u32 v44, v44, 5, v5
    v_add_u32 v44, 141824, v44
    v_add_u32 v3, 2, v3
    v_and_or_b32 v5, v3, 8, v2
    v_mul_u32_u24 v5, 288, v5
    v_lshl_add_u32 v5, v4, 3, v5
    v_and_b32 v45, 7, v3
    v_lshl_add_u32 v45, v45, 5, v5
    v_add_u32 v45, 141824, v45
    v_mul_u32_u24 v2, 288, v15
    v_lshl_add_u32 v2, v36, 3, v2
    v_add_u32 v43, 139520, v2
    s_lshl_b32 s13, s45, 8
    s_add_u32 s13, s13, 262144
    s_waitcnt lgkmcnt(0)
    s_add_u32 s33, s33, 0xd1a7653b
    s_bfe_u32 s40, s33, 0x80000
    s_bfe_u32 s41, s33, 0x80008
    s_bfe_u32 s42, s33, 0x80010
    s_bfe_u32 s43, s33, 0x80018
    s_mov_b32 s14, s33
    s_xor_b32 s15, s33, s8
    s_lshl_b32 s30, s53, 9
    s_add_u32 s30, s30, s7
    s_buffer_load_dword s10, s[36:39], s30 offset:0
    s_buffer_load_dword s10, s[36:39], s30 offset:64
    s_buffer_load_dword s10, s[36:39], s30 offset:128
    s_buffer_load_dword s10, s[36:39], s30 offset:192
    s_buffer_load_dword s10, s[36:39], s30 offset:256
    s_buffer_load_dword s10, s[36:39], s30 offset:320
    s_buffer_load_dword s10, s[36:39], s30 offset:384
    s_buffer_load_dword s10, s[36:39], s30 offset:448
    s_cmp_lt_u32 s2, 240
    s_cbranch_scc1 L_nrs
    v_mov_b32 v16, s14
    v_mov_b32 v17, s15
    v_mov_b32 v18, s14
    v_mov_b32 v19, s15
    s_and_b32 s32, s44, 1
    s_lshl_b32 s30, s32, 7
    s_add_u32 s30, s30, s13
    s_cmp_lg_u32 s53, 0
    s_cbranch_scc1 L_noid
    s_mov_b64 exec, 255
    buffer_store_dwordx4 v[16:19], v6, s[36:39], s30 offen sc1
    s_mov_b64 exec, -1
L_noid:
    s_branch L_rs
L_nrs:
    s_waitcnt vmcnt(0)
L_p1x:
    v_and_b32 v49, 0xffff0000, v16
    v_lshlrev_b32 v48, 16, v16
    v_and_b32 v51, 0xffff0000, v17
    v_lshlrev_b32 v50, 16, v17
    v_and_b32 v53, 0xffff0000, v18
    v_lshlrev_b32 v52, 16, v18
    v_and_b32 v55, 0xffff0000, v19
    v_lshlrev_b32 v54, 16, v19
    v_and_b32 v57, 0xffff0000, v20
    v_lshlrev_b32 v56, 16, v20
    v_and_b32 v59, 0xffff0000, v21
    v_lshlrev_b32 v58, 16, v21
    v_and_b32 v61, 0xffff0000, v22
    v_lshlrev_b32 v60, 16, v22
    v_and_b32 v63, 0xffff0000, v23
    v_lshlrev_b32 v62, 16, v23
    v_and_b32 v65, 0xffff0000, v24
    v_lshlrev_b32 v64, 16, v24
    v_and_b32 v67, 0xffff0000, v25
    v_lshlrev_b32 v66, 16, v25
    v_and_b32 v69, 0xffff0000, v26
    v_lshlrev_b32 v68, 16, v26
    v_and_b32 v71, 0xffff0000, v27
    v_lshlrev_b32 v70, 16, v27
    v_and_b32 v73, 0xffff0000, v28
    v_lshlrev_b32 v72, 16, v28
    v_and_b32 v75, 0xffff0000, v29
    v_lshlrev_b32 v74, 16, v29
    v_and_b32 v77, 0xffff0000, v30
    v_lshlrev_b32 v76, 16, v30
    v_and_b32 v79, 0xffff0000, v31
    v_lshlrev_b32 v78, 16, v31
    v_add_f32 v80, v48, v52
    v_add_f32 v81, v49, v53
    v_add_f32 v82, v50, v54
    v_add_f32 v83, v51, v55
    v_add_f32 v80, v80, v56
    v_add_f32 v81, v81, v57
    v_add_f32 v82, v82, v58
    v_add_f32 v83, v83, v59
    v_add_f32 v80, v80, v60
    v_add_f32 v81, v81, v61
    v_add_f32 v82, v82, v62
    v_add_f32 v83, v83, v63
    v_add_f32 v80, v80, v64
    v_add_f32 v81, v81, v65
    v_add_f32 v82, v82, v66
    v_add_f32 v83, v83, v67
    v_add_f32 v80, v80, v68
    v_add_f32 v81, v81, v69
    v_add_f32 v82, v82, v70
    v_add_f32 v83, v83, v71
    v_add_f32 v80, v80, v72
    v_add_f32 v81, v81, v73
    v_add_f32 v82, v82, v74
    v_add_f32 v83, v83, v75
    v_add_f32 v80, v80, v76
    v_add_f32 v81, v81, v77
    v_add_f32 v82, v82, v78
    v_add_f32 v83, v83, v79
    v_add_f32 v80, v80, v81
    v_add_f32 v82, v82, v83
    v_add_f32 v80, v80, v82
    s_nop 1
    v_add_f32_dpp v80, v80, v80 row_ror:8 row_mask:0xf bank_mask:0xf
    s_nop 1
    v_add_f32_dpp v80, v80, v80 row_ror:4 row_mask:0xf bank_mask:0xf
    s_nop 1
    v_add_f32_dpp v80, v80, v80 row_ror:2 row_mask:0xf bank_mask:0xf
    s_nop 1
    v_add_f32_dpp v80, v80, v80 row_ror:1 row_mask:0xf bank_mask:0xf
    v_mov_b32 v2, v80
    s_nop 1
    v_permlane16_swap_b32 v80, v2
    v_add_f32 v80, v80, v2
    v_mul_f32 v46, 0x3a800000, v80
    v_sub_f32 v84, v48, v46
    v_sub_f32 v85, v49, v46
    v_sub_f32 v86, v50, v46
    v_sub_f32 v87, v51, v46
    v_mul_f32 v80, v84, v84
    v_mul_f32 v81, v85, v85
    v_mul_f32 v82, v86, v86
    v_mul_f32 v83, v87, v87
    v_sub_f32 v84, v52, v46
    v_sub_f32 v85, v53, v46
    v_sub_f32 v86, v54, v46
    v_sub_f32 v87, v55, v46
    v_fmac_f32 v80, v84, v84
    v_fmac_f32 v81, v85, v85
    v_fmac_f32 v82, v86, v86
    v_fmac_f32 v83, v87, v87
    v_sub_f32 v84, v56, v46
    v_sub_f32 v85, v57, v46
    v_sub_f32 v86, v58, v46
    v_sub_f32 v87, v59, v46
    v_fmac_f32 v80, v84, v84
    v_fmac_f32 v81, v85, v85
    v_fmac_f32 v82, v86, v86
    v_fmac_f32 v83, v87, v87
    v_sub_f32 v84, v60, v46
    v_sub_f32 v85, v61, v46
    v_sub_f32 v86, v62, v46
    v_sub_f32 v87, v63, v46
    v_fmac_f32 v80, v84, v84
    v_fmac_f32 v81, v85, v85
    v_fmac_f32 v82, v86, v86
    v_fmac_f32 v83, v87, v87
    v_sub_f32 v84, v64, v46
    v_sub_f32 v85, v65, v46
    v_sub_f32 v86, v66, v46
    v_sub_f32 v87, v67, v46
    v_fmac_f32 v80, v84, v84
    v_fmac_f32 v81, v85, v85
    v_fmac_f32 v82, v86, v86
    v_fmac_f32 v83, v87, v87
    v_sub_f32 v84, v68, v46
    v_sub_f32 v85, v69, v46
    v_sub_f32 v86, v70, v46
    v_sub_f32 v87, v71, v46
    v_fmac_f32 v80, v84, v84
    v_fmac_f32 v81, v85, v85
    v_fmac_f32 v82, v86, v86
    v_fmac_f32 v83, v87, v87
    v_sub_f32 v84, v72, v46
    v_sub_f32 v85, v73, v46
    v_sub_f32 v86, v74, v46
    v_sub_f32 v87, v75, v46
    v_fmac_f32 v80, v84, v84
    v_fmac_f32 v81, v85, v85
    v_fmac_f32 v82, v86, v86
    v_fmac_f32 v83, v87, v87
    v_sub_f32 v84, v76, v46
    v_sub_f32 v85, v77, v46
    v_sub_f32 v86, v78, v46
    v_sub_f32 v87, v79, v46
    v_fmac_f32 v80, v84, v84
    v_fmac_f32 v81, v85, v85
    v_fmac_f32 v82, v86, v86
    v_fmac_f32 v83, v87, v87
    v_add_f32 v80, v80, v81
    v_add_f32 v82, v82, v83
    v_add_f32 v80, v80, v82
    s_nop 1
    v_add_f32_dpp v80, v80, v80 row_ror:8 row_mask:0xf bank_mask:0xf
    s_nop 1
    v_add_f32_dpp v80, v80, v80 row_ror:4 row_mask:0xf bank_mask:0xf
    s_nop 1
    v_add_f32_dpp v80, v80, v80 row_ror:2 row_mask:0xf bank_mask:0xf
    s_nop 1
    v_add_f32_dpp v80, v80, v80 row_ror:1 row_mask:0xf bank_mask:0xf
    v_mov_b32 v2, v80
    s_nop 1
    v_permlane16_swap_b32 v80, v2
    v_add_f32 v80, v80, v2
    v_mul_f32 v80, 0x3a800000, v80
    v_cvt_pk_bf16_f32 v2, v46, v80
    v_and_b32 v80, 0xffff0000, v2
    v_lshlrev_b32 v46, 16, v2
    v_add_f32 v80, 0x3727c5ac, v80
    v_cvt_pk_bf16_f32 v2, v80, v80
    v_lshlrev_b32 v80, 16, v2
    v_sqrt_f32 v80, v80
    s_nop 0
    v_cvt_pk_bf16_f32 v2, v80, v80
    v_lshlrev_b32 v80, 16, v2
    v_rcp_f32 v81, v80
    s_add_u32 s30, s13, 128
    s_buffer_load_dwordx2 s[16:17], s[36:39], s13
    s_buffer_load_dwordx2 s[18:19], s[36:39], s30
    v_sub_f32 v2, v48, v46
    v_sub_f32 v3, v49, v46
    v_cvt_pk_bf16_f32 v2, v2, v3
    v_and_b32 v49, 0xffff0000, v2
    v_lshlrev_b32 v48, 16, v2
    v_mul_f32 v2, v48, v81
    v_fma_f32 v3, -v2, v80, v48
    v_fma_f32 v48, v3, v81, v2
    v_mul_f32 v2, v49, v81
    v_fma_f32 v3, -v2, v80, v49
    v_fma_f32 v49, v3, v81, v2
    v_cvt_pk_bf16_f32 v16, v48, v49
    v_sub_f32 v2, v50, v46
    v_sub_f32 v3, v51, v46
    v_cvt_pk_bf16_f32 v2, v2, v3
    v_and_b32 v51, 0xffff0000, v2
    v_lshlrev_b32 v50, 16, v2
    v_mul_f32 v2, v50, v81
    v_fma_f32 v3, -v2, v80, v50
    v_fma_f32 v50, v3, v81, v2
    v_mul_f32 v2, v51, v81
    v_fma_f32 v3, -v2, v80, v51
    v_fma_f32 v51, v3, v81, v2
    v_cvt_pk_bf16_f32 v17, v50, v51
    v_sub_f32 v2, v52, v46
    v_sub_f32 v3, v53, v46
    v_cvt_pk_bf16_f32 v2, v2, v3
    v_and_b32 v53, 0xffff0000, v2
    v_lshlrev_b32 v52, 16, v2
    v_mul_f32 v2, v52, v81
    v_fma_f32 v3, -v2, v80, v52
    v_fma_f32 v52, v3, v81, v2
    v_mul_f32 v2, v53, v81
    v_fma_f32 v3, -v2, v80, v53
    v_fma_f32 v53, v3, v81, v2
    v_cvt_pk_bf16_f32 v18, v52, v53
    v_sub_f32 v2, v54, v46
    v_sub_f32 v3, v55, v46
    v_cvt_pk_bf16_f32 v2, v2, v3
    v_and_b32 v55, 0xffff0000, v2
    v_lshlrev_b32 v54, 16, v2
    v_mul_f32 v2, v54, v81
    v_fma_f32 v3, -v2, v80, v54
    v_fma_f32 v54, v3, v81, v2
    v_mul_f32 v2, v55, v81
    v_fma_f32 v3, -v2, v80, v55
    v_fma_f32 v55, v3, v81, v2
    v_cvt_pk_bf16_f32 v19, v54, v55
    v_sub_f32 v2, v56, v46
    v_sub_f32 v3, v57, v46
    v_cvt_pk_bf16_f32 v2, v2, v3
    v_and_b32 v57, 0xffff0000, v2
    v_lshlrev_b32 v56, 16, v2
    v_mul_f32 v2, v56, v81
    v_fma_f32 v3, -v2, v80, v56
    v_fma_f32 v56, v3, v81, v2
    v_mul_f32 v2, v57, v81
    v_fma_f32 v3, -v2, v80, v57
    v_fma_f32 v57, v3, v81, v2
    v_cvt_pk_bf16_f32 v20, v56, v57
    v_sub_f32 v2, v58, v46
    v_sub_f32 v3, v59, v46
    v_cvt_pk_bf16_f32 v2, v2, v3
    v_and_b32 v59, 0xffff0000, v2
    v_lshlrev_b32 v58, 16, v2
    v_mul_f32 v2, v58, v81
    v_fma_f32 v3, -v2, v80, v58
    v_fma_f32 v58, v3, v81, v2
    v_mul_f32 v2, v59, v81
    v_fma_f32 v3, -v2, v80, v59
    v_fma_f32 v59, v3, v81, v2
    v_cvt_pk_bf16_f32 v21, v58, v59
    v_sub_f32 v2, v60, v46
    v_sub_f32 v3, v61, v46
    v_cvt_pk_bf16_f32 v2, v2, v3
    v_and_b32 v61, 0xffff0000, v2
    v_lshlrev_b32 v60, 16, v2
    v_mul_f32 v2, v60, v81
    v_fma_f32 v3, -v2, v80, v60
    v_fma_f32 v60, v3, v81, v2
    v_mul_f32 v2, v61, v81
    v_fma_f32 v3, -v2, v80, v61
    v_fma_f32 v61, v3, v81, v2
    v_cvt_pk_bf16_f32 v22, v60, v61
    v_sub_f32 v2, v62, v46
    v_sub_f32 v3, v63, v46
    v_cvt_pk_bf16_f32 v2, v2, v3
    v_and_b32 v63, 0xffff0000, v2
    v_lshlrev_b32 v62, 16, v2
    v_mul_f32 v2, v62, v81
    v_fma_f32 v3, -v2, v80, v62
    v_fma_f32 v62, v3, v81, v2
    v_mul_f32 v2, v63, v81
    v_fma_f32 v3, -v2, v80, v63
    v_fma_f32 v63, v3, v81, v2
    v_cvt_pk_bf16_f32 v23, v62, v63
    ds_write_b128 v12, v[16:19]
    ds_write_b128 v12, v[20:23] offset:512
    v_mul_u32_u24 v2, 1056, v8
    v_lshl_add_u32 v2, v7, 4, v2
    v_and_b32 v3, 8, v1
    v_lshl_add_u32 v2, v3, 6, v2
    v_add_u32 v46, 131072, v2
    v_bfe_u32 v2, v1, 2, 2
    v_lshl_add_u32 v3, v7, 3, v2
    v_lshlrev_b32 v3, 7, v3
    v_and_b32 v4, 1, v1
    v_lshl_add_u32 v3, v4, 3, v3
    v_and_b32 v2, 2, v2
    v_and_b32 v4, 1, v7
    v_lshl_or_b32 v2, v4, 2, v2
    v_bfe_u32 v4, v1, 1, 1
    v_or_b32 v2, v2, v4
    s_lshl_b32 s30, s53, 1
    v_xor_b32 v4, s30, v2
    v_lshl_add_u32 v48, v4, 4, v3
    v_add_u32 v49, 0x10000, v48
    v_and_b32 v2, 1, v1
    v_lshlrev_b32 v2, 8, v2
    v_bfe_u32 v3, v1, 1, 2
    v_lshl_add_u32 v2, v3, 6, v2
    v_lshl_add_u32 v47, v7, 4, v2
    s_lshl_b32 s30, s53, 9
    s_add_u32 s30, s30, s7
    v_add_u32 v47, s30, v47
    v_mov_b32 v50, 0x1ff
    s_waitcnt lgkmcnt(0)
    s_cmp_eq_u32 s3, 7
    s_cbranch_scc1 L_pad_l0
L_ret_l0:
    s_branch L_pb_cs
L_rs:
    v_mov_b32 v88, -1
    v_mov_b32 v89, -1
    v_mov_b32 v90, -1
    v_mov_b32 v91, -1
    s_lshl1_add_u32 s31, s53, s32
    s_lshl4_add_u32 s30, s45, s31
    s_lshl_b32 s30, s30, 13
    s_add_u32 s20, s30, 2097152
    s_add_u32 s21, s20, 65536
    s_xor_b32 s30, s31, s45
    s_lshl3_add_u32 s30, s31, s30
    s_lshl_b32 s22, s30, 11
    s_lshl_b32 s23, s30, 10
    s_add_u32 s23, s23, 131072
    s_lshl_b32 s30, s30, 7
    s_cmp_lt_u32 s31, 7
    s_cselect_b32 s21, s21, s20
    s_cselect_b32 s23, s23, 268435456
    v_lshrrev_b32 v2, 5, v1
    v_and_b32 v3, 3, v1
    v_lshlrev_b32 v3, 3, v3
    v_lshl_add_u32 v3, v2, 5, v3
    buffer_load_dwordx2 v[52:53], v3, s[60:63], s30 offen offset:0
    buffer_load_dwordx2 v[54:55], v3, s[60:63], s30 offen offset:64
    buffer_store_dwordx4 v[88:91], v6, s[36:39], s23 offen sc1
    s_lshl2_add_u32 s30, s5, s53
    s_lshl1_add_u32 s30, s30, s32
    s_lshr_b32 s31, s45, 2
    s_lshl2_add_u32 s30, s30, s31
    s_lshl_b32 s30, s30, 9
    s_add_u32 s30, s30, 1048576
    v_lshl_add_u32 v2, v2, 9, v6
    buffer_store_dwordx4 v[88:91], v2, s[36:39], s30 offen sc1
    v_add_u32 v4, 4096, v6
    s_branch L_rs2
    .p2align 12
L_pb_cs:
    s_barrier
    ds_read_b128 v[52:55], v46 offset:0
    ds_read_b64_tr_b16 v[84:85], v48 offset:16384
    ds_read_b64_tr_b16 v[86:87], v48 offset:16896
    ds_read_b64_tr_b16 v[116:117], v49 offset:16384
    ds_read_b64_tr_b16 v[118:119], v49 offset:16896
    ds_read_b128 v[56:59], v46 offset:64
    ds_read_b64_tr_b16 v[88:89], v48 offset:20480
    ds_read_b64_tr_b16 v[90:91], v48 offset:20992
    ds_read_b64_tr_b16 v[120:121], v49 offset:20480
    ds_read_b64_tr_b16 v[122:123], v49 offset:20992
    ds_read_b128 v[60:63], v46 offset:128
    ds_read_b64_tr_b16 v[92:93], v48 offset:24576
    ds_read_b64_tr_b16 v[94:95], v48 offset:25088
    ds_read_b64_tr_b16 v[124:125], v49 offset:24576
    ds_read_b64_tr_b16 v[126:127], v49 offset:25088
    s_waitcnt lgkmcnt(10)
    v_mfma_f32_16x16x32_bf16 v[148:151], v[84:87], v[52:55], 0
    v_mfma_f32_16x16x32_bf16 v[152:155], v[116:119], v[52:55], 0
    ds_read_b128 v[64:67], v46 offset:192
    ds_read_b64_tr_b16 v[96:97], v48 offset:28672
    ds_read_b64_tr_b16 v[98:99], v48 offset:29184
    ds_read_b64_tr_b16 v[128:129], v49 offset:28672
    ds_read_b64_tr_b16 v[130:131], v49 offset:29184
    s_waitcnt lgkmcnt(10)
    v_mfma_f32_16x16x32_bf16 v[148:151], v[88:91], v[56:59], v[148:151]
    v_mfma_f32_16x16x32_bf16 v[152:155], v[120:123], v[56:59], v[152:155]
    ds_read_b128 v[68:71], v46 offset:256
    ds_read_b64_tr_b16 v[100:101], v48 offset:49152
    ds_read_b64_tr_b16 v[102:103], v48 offset:49664
    ds_read_b64_tr_b16 v[132:133], v49 offset:49152
    ds_read_b64_tr_b16 v[134:135], v49 offset:49664
    s_waitcnt lgkmcnt(10)
    v_mfma_f32_16x16x32_bf16 v[148:151], v[92:95], v[60:63], v[148:151]
    v_mfma_f32_16x16x32_bf16 v[152:155], v[124:127], v[60:63], v[152:155]
    ds_read_b128 v[72:75], v46 offset:320
    ds_read_b64_tr_b16 v[104:105], v48 offset:53248
    ds_read_b64_tr_b16 v[106:107], v48 offset:53760
    ds_read_b64_tr_b16 v[136:137], v49 offset:53248
    ds_read_b64_tr_b16 v[138:139], v49 offset:53760
    s_waitcnt lgkmcnt(10)
    v_mfma_f32_16x16x32_bf16 v[148:151], v[96:99], v[64:67], v[148:151]
    v_mfma_f32_16x16x32_bf16 v[152:155], v[128:131], v[64:67], v[152:155]
    ds_read_b128 v[76:79], v46 offset:384
    ds_read_b64_tr_b16 v[108:109], v48 offset:57344
    ds_read_b64_tr_b16 v[110:111], v48 offset:57856
    ds_read_b64_tr_b16 v[140:141], v49 offset:57344
    ds_read_b64_tr_b16 v[142:143], v49 offset:57856
    s_waitcnt lgkmcnt(10)
    v_mfma_f32_16x16x32_bf16 v[148:151], v[100:103], v[68:71], v[148:151]
    v_mfma_f32_16x16x32_bf16 v[152:155], v[132:135], v[68:71], v[152:155]
    ds_read_b128 v[80:83], v46 offset:448
    ds_read_b64_tr_b16 v[112:113], v48 offset:61440
    ds_read_b64_tr_b16 v[114:115], v48 offset:61952
    ds_read_b64_tr_b16 v[144:145], v49 offset:61440
    ds_read_b64_tr_b16 v[146:147], v49 offset:61952
    s_waitcnt lgkmcnt(10)
    v_mfma_f32_16x16x32_bf16 v[148:151], v[104:107], v[72:75], v[148:151]
    v_mfma_f32_16x16x32_bf16 v[152:155], v[136:139], v[72:75], v[152:155]
    s_waitcnt lgkmcnt(5)
    v_mfma_f32_16x16x32_bf16 v[148:151], v[108:111], v[76:79], v[148:151]
    v_mfma_f32_16x16x32_bf16 v[152:155], v[140:143], v[76:79], v[152:155]
    s_waitcnt lgkmcnt(0)
    v_mfma_f32_16x16x32_bf16 v[148:151], v[112:115], v[80:83], v[148:151]
    v_mfma_f32_16x16x32_bf16 v[152:155], v[144:147], v[80:83], v[152:155]
    s_nop 7
    v_add_f32_dpp v148, v152, v148 row_ror:8 row_mask:0xf bank_mask:0xf
    v_add_f32_dpp v149, v153, v149 row_ror:8 row_mask:0xf bank_mask:0xf
    v_add_f32_dpp v150, v154, v150 row_ror:8 row_mask:0xf bank_mask:0xf
    v_add_f32_dpp v151, v155, v151 row_ror:8 row_mask:0xf bank_mask:0xf
    s_mov_b32 s51, 0
    s_xor_b64 s[16:17], s[16:17], s[14:15]
    s_xor_b64 s[18:19], s[18:19], s[14:15]
    s_or_b64 s[16:17], s[16:17], s[18:19]
    s_cbranch_scc0 L_idokn
    v_and_b32 v3, 1, v1
    v_lshlrev_b32 v3, 7, v3
    s_mov_b32 s49, 0
L_idn:
    buffer_load_dwordx2 v[152:153], v3, s[36:39], s13 offen sc1
    s_add_u32 s49, s49, 1
    s_waitcnt vmcnt(0)
    v_xor_b32 v152, s14, v152
    v_xor_b32 v153, s15, v153
    v_lshrrev_b32 v2, 4, v153
    v_or_b32 v2, v2, v152
    v_cmp_ne_u32 vcc, 0, v2
    s_cmp_lt_u32 s49, 100000
    s_cselect_b64 vcc, vcc, 0
    s_cmp_lg_u64 vcc, 0
    s_cbranch_scc1 L_idn
    v_or_b32 v2, v152, v153
    v_cmp_ne_u32 vcc, 0, v2
    s_cmp_eq_u64 vcc, 0
    s_cselect_b32 s51, 0, 268435456
L_idokn:
    s_lshr_b32 s30, s51, 20
    s_or_b32 s30, s30, s40
    s_xor_b32 s52, s51, 268435456
    v_bfi_b32 v148, v50, s30, v148
    v_bfi_b32 v149, v9, s41, v149
    v_bfi_b32 v150, v9, s42, v150
    v_bfi_b32 v151, v9, s43, v151
    s_mov_b64 exec, s[34:35]
    buffer_store_dwordx4 v[148:151], v47, s[36:39], s51 offen
    s_cmp_eq_u32 s51, 0
    s_cbranch_scc1 L_pubs
    buffer_store_dwordx4 v[148:151], v47, s[36:39], s52 offen sc1
L_pubs:
    s_mov_b64 exec, -1
    s_barrier
    s_branch L_s1done
L_rs2:
    s_mov_b32 s24, -1
    s_branch L_u_ok
L_u_0:
    s_waitcnt vmcnt(0)
    s_add_u32 s30, s13, 128
    s_buffer_load_dwordx2 s[16:17], s[36:39], s13
    s_buffer_load_dwordx2 s[18:19], s[36:39], s30
    s_waitcnt lgkmcnt(0)
    s_mov_b32 s51, 0
    s_xor_b64 s[16:17], s[16:17], s[14:15]
    s_xor_b64 s[18:19], s[18:19], s[14:15]
    s_or_b64 s[16:17], s[16:17], s[18:19]
    s_cbranch_scc0 L_idokr
    v_and_b32 v3, 1, v1
    v_lshlrev_b32 v3, 7, v3
    s_mov_b32 s49, 0
L_idr:
    buffer_load_dwordx2 v[124:125], v3, s[36:39], s13 offen sc1
    s_add_u32 s49, s49, 1
    s_waitcnt vmcnt(0)
    v_xor_b32 v124, s14, v124
    v_xor_b32 v125, s15, v125
    v_lshrrev_b32 v2, 4, v125
    v_or_b32 v2, v2, v124
    v_cmp_ne_u32 vcc, 0, v2
    s_cmp_lt_u32 s49, 100000
    s_cselect_b64 vcc, vcc, 0
    s_cmp_lg_u64 vcc, 0
    s_cbranch_scc1 L_idr
    v_or_b32 v2, v124, v125
    v_cmp_ne_u32 vcc, 0, v2
    s_cmp_eq_u64 vcc, 0
    s_cselect_b32 s51, 0, 268435456
L_idokr:
    v_mov_b32 v116, s40
    v_mov_b32 v117, s41
    v_mov_b32 v118, s42
    v_mov_b32 v119, s43
    s_lshl_b32 s30, s53, 9
    s_add_u32 s30, s30, s7
    v_add_u32 v2, s30, v6
    s_xor_b32 s52, s51, 268435456
    s_mov_b32 exec_hi, 0
    buffer_store_dwordx4 v[116:119], v2, s[36:39], s51 offen
    s_cmp_eq_u32 s51, 0
    s_cbranch_scc1 L_pubi
    buffer_store_dwordx4 v[116:119], v2, s[36:39], s52 offen sc1
L_pubi:
    s_mov_b32 exec_hi, -1
    s_mov_b32 s24, 0
    s_barrier
    buffer_load_dwordx4 v[84:87], v6, s[36:39], s20 offen offset:0 sc1
    buffer_load_dwordx4 v[88:91], v6, s[36:39], s20 offen offset:1024 sc1
    buffer_load_dwordx4 v[92:95], v4, s[36:39], s20 offen offset:0 sc1
    buffer_load_dwordx4 v[96:99], v4, s[36:39], s20 offen offset:1024 sc1
    buffer_load_dwordx4 v[100:103], v6, s[36:39], s21 offen offset:0 sc1
    buffer_load_dwordx4 v[104:107], v6, s[36:39], s21 offen offset:1024 sc1
    buffer_load_dwordx4 v[108:111], v4, s[36:39], s21 offen offset:0 sc1
    buffer_load_dwordx4 v[112:115], v4, s[36:39], s21 offen offset:1024 sc1
L_u_go:
    s_mov_b32 s49, 0
    s_waitcnt vmcnt(7)
    v_xor_b32 v116, s40, v84
    v_xor_b32 v117, s41, v85
    v_xor_b32 v118, s42, v86
    v_xor_b32 v119, s43, v87
    v_or_b32 v2, v116, v117
    v_or3_b32 v2, v2, v118, v119
    s_waitcnt vmcnt(6)
    v_xor_b32 v120, s40, v88
    v_xor_b32 v121, s41, v89
    v_xor_b32 v122, s42, v90
    v_xor_b32 v123, s43, v91
    v_or3_b32 v2, v2, v120, v121
    v_or3_b32 v2, v2, v122, v123
    s_waitcnt vmcnt(5)
    v_xor_b32 v124, s40, v92
    v_xor_b32 v125, s41, v93
    v_xor_b32 v126, s42, v94
    v_xor_b32 v127, s43, v95
    v_or3_b32 v2, v2, v124, v125
    v_or3_b32 v2, v2, v126, v127
    s_waitcnt vmcnt(4)
    v_xor_b32 v128, s40, v96
    v_xor_b32 v129, s41, v97
    v_xor_b32 v130, s42, v98
    v_xor_b32 v131, s43, v99
    v_or3_b32 v2, v2, v128, v129
    v_or3_b32 v2, v2, v130, v131
    s_waitcnt vmcnt(3)
    v_xor_b32 v132, s40, v100
    v_xor_b32 v133, s41, v101
    v_xor_b32 v134, s42, v102
    v_xor_b32 v135, s43, v103
    v_or3_b32 v2, v2, v132, v133
    v_or3_b32 v2, v2, v134, v135
    s_waitcnt vmcnt(2)
    v_xor_b32 v136, s40, v104
    v_xor_b32 v137, s41, v105
    v_xor_b32 v138, s42, v106
    v_xor_b32 v139, s43, v107
    v_or3_b32 v2, v2, v136, v137
    v_or3_b32 v2, v2, v138, v139
    s_waitcnt vmcnt(1)
    v_xor_b32 v140, s40, v108
    v_xor_b32 v141, s41, v109
    v_xor_b32 v142, s42, v110
    v_xor_b32 v143, s43, v111
    v_or3_b32 v2, v2, v140, v141
    v_or3_b32 v2, v2, v142, v143
    s_waitcnt vmcnt(0)
    v_xor_b32 v144, s40, v112
    v_xor_b32 v145, s41, v113
    v_xor_b32 v146, s42, v114
    v_xor_b32 v147, s43, v115
    v_or3_b32 v2, v2, v144, v145
    v_or3_b32 v2, v2, v146, v147
    v_cmp_ne_u32_sdwa vcc, v2, v10 src0_sel:BYTE_0 src1_sel:DWORD
    s_cbranch_vccz L_u_ok
    s_mov_b32 s49, 0
    s_mov_b32 s32, 255
L_u_chk:
    s_waitcnt vmcnt(0)
    s_and_b32 s30, s32, 15
    s_cbranch_scc0 L_u_0_4
    s_and_b32 s30, s32, 3
    s_cbranch_scc0 L_u_0_2
    s_and_b32 s30, s32, 1
    s_cbranch_scc0 L_u_0_1
    v_xor_b32 v116, s40, v84
    v_xor_b32 v117, s41, v85
    v_xor_b32 v118, s42, v86
    v_xor_b32 v119, s43, v87
    v_or3_b32 v2, v116, v117, v118
    v_or_b32 v2, v2, v119
    v_and_b32 v2, v9, v2
    v_cmp_ne_u32 vcc, 0, v2
    s_bitset0_b32 s32, 0
    s_cbranch_vccz L_u_0_1
    buffer_load_dwordx4 v[84:87], v6, s[36:39], s20 offen offset:0 sc1
    s_bitset1_b32 s32, 0
L_u_0_1:
    s_and_b32 s30, s32, 2
    s_cbranch_scc0 L_u_1_1
    v_xor_b32 v120, s40, v88
    v_xor_b32 v121, s41, v89
    v_xor_b32 v122, s42, v90
    v_xor_b32 v123, s43, v91
    v_or3_b32 v2, v120, v121, v122
    v_or_b32 v2, v2, v123
    v_and_b32 v2, v9, v2
    v_cmp_ne_u32 vcc, 0, v2
    s_bitset0_b32 s32, 1
    s_cbranch_vccz L_u_1_1
    buffer_load_dwordx4 v[88:91], v6, s[36:39], s20 offen offset:1024 sc1
    s_bitset1_b32 s32, 1
L_u_1_1:
L_u_0_2:
    s_and_b32 s30, s32, 12
    s_cbranch_scc0 L_u_2_2
    s_and_b32 s30, s32, 4
    s_cbranch_scc0 L_u_2_1
    v_xor_b32 v124, s40, v92
    v_xor_b32 v125, s41, v93
    v_xor_b32 v126, s42, v94
    v_xor_b32 v127, s43, v95
    v_or3_b32 v2, v124, v125, v126
    v_or_b32 v2, v2, v127
    v_and_b32 v2, v9, v2
    v_cmp_ne_u32 vcc, 0, v2
    s_bitset0_b32 s32, 2
    s_cbranch_vccz L_u_2_1
    buffer_load_dwordx4 v[92:95], v4, s[36:39], s20 offen offset:0 sc1
    s_bitset1_b32 s32, 2
L_u_2_1:
    s_and_b32 s30, s32, 8
    s_cbranch_scc0 L_u_3_1
    v_xor_b32 v128, s40, v96
    v_xor_b32 v129, s41, v97
    v_xor_b32 v130, s42, v98
    v_xor_b32 v131, s43, v99
    v_or3_b32 v2, v128, v129, v130
    v_or_b32 v2, v2, v131
    v_and_b32 v2, v9, v2
    v_cmp_ne_u32 vcc, 0, v2
    s_bitset0_b32 s32, 3
    s_cbranch_vccz L_u_3_1
    buffer_load_dwordx4 v[96:99], v4, s[36:39], s20 offen offset:1024 sc1
    s_bitset1_b32 s32, 3
L_u_3_1:
L_u_2_2:
L_u_0_4:
    s_and_b32 s30, s32, 240
    s_cbranch_scc0 L_u_4_4
    s_and_b32 s30, s32, 48
    s_cbranch_scc0 L_u_4_2
    s_and_b32 s30, s32, 16
    s_cbranch_scc0 L_u_4_1
    v_xor_b32 v132, s40, v100
    v_xor_b32 v133, s41, v101
    v_xor_b32 v134, s42, v102
    v_xor_b32 v135, s43, v103
    v_or3_b32 v2, v132, v133, v134
    v_or_b32 v2, v2, v135
    v_and_b32 v2, v9, v2
    v_cmp_ne_u32 vcc, 0, v2
    s_bitset0_b32 s32, 4
    s_cbranch_vccz L_u_4_1
    buffer_load_dwordx4 v[100:103], v6, s[36:39], s21 offen offset:0 sc1
    s_bitset1_b32 s32, 4
L_u_4_1:
    s_and_b32 s30, s32, 32
    s_cbranch_scc0 L_u_5_1
    v_xor_b32 v136, s40, v104
    v_xor_b32 v137, s41, v105
    v_xor_b32 v138, s42, v106
    v_xor_b32 v139, s43, v107
    v_or3_b32 v2, v136, v137, v138
    v_or_b32 v2, v2, v139
    v_and_b32 v2, v9, v2
    v_cmp_ne_u32 vcc, 0, v2
    s_bitset0_b32 s32, 5
    s_cbranch_vccz L_u_5_1
    buffer_load_dwordx4 v[104:107], v6, s[36:39], s21 offen offset:1024 sc1
    s_bitset1_b32 s32, 5
L_u_5_1:
L_u_4_2:
    s_and_b32 s30, s32, 192
    s_cbranch_scc0 L_u_6_2
    s_and_b32 s30, s32, 64
    s_cbranch_scc0 L_u_6_1
    v_xor_b32 v140, s40, v108
    v_xor_b32 v141, s41, v109
    v_xor_b32 v142, s42, v110
    v_xor_b32 v143, s43, v111
    v_or3_b32 v2, v140, v141, v142
    v_or_b32 v2, v2, v143
    v_and_b32 v2, v9, v2
    v_cmp_ne_u32 vcc, 0, v2
    s_bitset0_b32 s32, 6
    s_cbranch_vccz L_u_6_1
    buffer_load_dwordx4 v[108:111], v4, s[36:39], s21 offen offset:0 sc1
    s_bitset1_b32 s32, 6
L_u_6_1:
    s_and_b32 s30, s32, 128
    s_cbranch_scc0 L_u_7_1
    v_xor_b32 v144, s40, v112
    v_xor_b32 v145, s41, v113
    v_xor_b32 v146, s42, v114
    v_xor_b32 v147, s43, v115
    v_or3_b32 v2, v144, v145, v146
    v_or_b32 v2, v2, v147
    v_and_b32 v2, v9, v2
    v_cmp_ne_u32 vcc, 0, v2
    s_bitset0_b32 s32, 7
    s_cbranch_vccz L_u_7_1
    buffer_load_dwordx4 v[112:115], v4, s[36:39], s21 offen offset:1024 sc1
    s_bitset1_b32 s32, 7
L_u_7_1:
L_u_6_2:
L_u_4_4:
L_u_0_8:
    s_add_u32 s49, s49, 1
    s_cmp_lt_u32 s49, 100000
    s_cselect_b32 s32, s32, 0
    s_andn2_b32 s32, s32, s24
    s_cbranch_scc1 L_u_chk
L_u_ok:
    v_or3_b32 v2, v116, v120, v124
    v_or3_b32 v2, v2, v128, v132
    v_or3_b32 v2, v2, v136, v140
    v_or_b32 v2, v2, v144
    v_and_b32 v2, 0x100, v2
    v_cmp_ne_u32 vcc, 0, v2
    s_lshl2_add_u32 s31, s53, 155024
    s_cmp_eq_u64 vcc, 0
    s_cselect_b32 s30, s51, 268435456
    v_mov_b32 v2, s31
    v_mov_b32 v3, s30
    ds_write_b32 v2, v3
    v_and_b32 v116, 0xfffffeff, v116
    v_and_b32 v120, 0xfffffeff, v120
    v_and_b32 v124, 0xfffffeff, v124
    v_and_b32 v128, 0xfffffeff, v128
    v_and_b32 v132, 0xfffffeff, v132
    v_and_b32 v136, 0xfffffeff, v136
    v_and_b32 v140, 0xfffffeff, v140
    v_and_b32 v144, 0xfffffeff, v144
    v_pk_add_f32 v[116:117], v[116:117], v[124:125]
    v_pk_add_f32 v[118:119], v[118:119], v[126:127]
    v_pk_add_f32 v[120:121], v[120:121], v[128:129]
    v_pk_add_f32 v[122:123], v[122:123], v[130:131]
    v_cvt_pk_bf16_f32 v124, v116, v117
    v_cvt_pk_bf16_f32 v125, v118, v119
    v_cvt_pk_bf16_f32 v126, v120, v121
    v_cvt_pk_bf16_f32 v127, v122, v123
    v_pk_add_f32 v[132:133], v[132:133], v[140:141]
    v_pk_add_f32 v[134:135], v[134:135], v[142:143]
    v_pk_add_f32 v[136:137], v[136:137], v[144:145]
    v_pk_add_f32 v[138:139], v[138:139], v[146:147]
    v_cvt_pk_bf16_f32 v140, v132, v133
    v_cvt_pk_bf16_f32 v141, v134, v135
    v_cvt_pk_bf16_f32 v142, v136, v137
    v_cvt_pk_bf16_f32 v143, v138, v139
    v_and_b32 v133, 0xffff0000, v140
    v_lshlrev_b32 v132, 16, v140
    v_and_b32 v135, 0xffff0000, v52
    v_lshlrev_b32 v134, 16, v52
    v_add_f32 v132, v132, v134
    v_add_f32 v133, v133, v135
    v_cvt_pk_bf16_f32 v2, v132, v133
    v_and_b32 v133, 0xffff0000, v2
    v_lshlrev_b32 v132, 16, v2
    v_max_f32 v132, 0, v132
    v_max_f32 v133, 0, v133
    v_mul_f32 v132, v132, v132
    v_mul_f32 v133, v133, v133
    v_cvt_pk_bf16_f32 v140, v132, v133
    v_min_u32 v140, -2, v140
    v_and_b32 v133, 0xffff0000, v141
    v_lshlrev_b32 v132, 16, v141
    v_and_b32 v135, 0xffff0000, v53
    v_lshlrev_b32 v134, 16, v53
    v_add_f32 v132, v132, v134
    v_add_f32 v133, v133, v135
    v_cvt_pk_bf16_f32 v2, v132, v133
    v_and_b32 v133, 0xffff0000, v2
    v_lshlrev_b32 v132, 16, v2
    v_max_f32 v132, 0, v132
    v_max_f32 v133, 0, v133
    v_mul_f32 v132, v132, v132
    v_mul_f32 v133, v133, v133
    v_cvt_pk_bf16_f32 v141, v132, v133
    v_min_u32 v141, -2, v141
    v_and_b32 v133, 0xffff0000, v142
    v_lshlrev_b32 v132, 16, v142
    v_and_b32 v135, 0xffff0000, v54
    v_lshlrev_b32 v134, 16, v54
    v_add_f32 v132, v132, v134
    v_add_f32 v133, v133, v135
    v_cvt_pk_bf16_f32 v2, v132, v133
    v_and_b32 v133, 0xffff0000, v2
    v_lshlrev_b32 v132, 16, v2
    v_max_f32 v132, 0, v132
    v_max_f32 v133, 0, v133
    v_mul_f32 v132, v132, v132
    v_mul_f32 v133, v133, v133
    v_cvt_pk_bf16_f32 v142, v132, v133
    v_min_u32 v142, -2, v142
    v_and_b32 v133, 0xffff0000, v143
    v_lshlrev_b32 v132, 16, v143
    v_and_b32 v135, 0xffff0000, v55
    v_lshlrev_b32 v134, 16, v55
    v_add_f32 v132, v132, v134
    v_add_f32 v133, v133, v135
    v_cvt_pk_bf16_f32 v2, v132, v133
    v_and_b32 v133, 0xffff0000, v2
    v_lshlrev_b32 v132, 16, v2
    v_max_f32 v132, 0, v132
    v_max_f32 v133, 0, v133
    v_mul_f32 v132, v132, v132
    v_mul_f32 v133, v133, v133
    v_cvt_pk_bf16_f32 v143, v132, v133
    v_min_u32 v143, -2, v143
    v_mov_b32 v2, 155024
    s_waitcnt lgkmcnt(0)
    s_cmp_lg_u32 s24, 0
    s_cbranch_scc1 L_u_0
    s_barrier
    ds_read_b128 v[132:135], v2
    s_waitcnt lgkmcnt(0)
    v_or3_b32 v2, v132, v133, v134
    v_or_b32 v2, v2, v135
    v_lshrrev_b32 v2, 20, v2
    v_or_b32 v2, s40, v2
    v_lshl_or_b32 v116, v124, 16, v2
    v_bfi_b32 v117, v9, s41, v124
    v_lshl_or_b32 v118, v125, 16, s42
    v_bfi_b32 v119, v9, s43, v125
    buffer_store_dwordx4 v[116:119], v6, s[36:39], s22 offen offset:0 sc1
    v_lshl_or_b32 v120, v126, 16, v2
    v_bfi_b32 v121, v9, s41, v126
    v_lshl_or_b32 v122, v127, 16, s42
    v_bfi_b32 v123, v9, s43, v127
    buffer_store_dwordx4 v[120:123], v6, s[36:39], s22 offen offset:1024 sc1
    buffer_store_dwordx4 v[140:143], v6, s[36:39], s23 offen sc1
    s_barrier
L_s1done:
    v_readfirstlane_b32 s30, v37
    s_and_b32 s31, s30, 0x7ff
    s_buffer_load_dwordx4 s[16:19], s[56:59], s30
    s_buffer_load_dwordx4 s[20:23], s[64:67], s31
    s_lshl_b32 s13, s53, 15
    v_and_b32 v2, 15, v1
    v_mul_u32_u24 v2, 288, v2
    v_lshl_add_u32 v2, v7, 4, v2
    v_add_u32 v46, 141824, v2
    v_bfe_u32 v2, v1, 2, 2
    v_and_b32 v4, 1, v1
    v_lshlrev_b32 v4, 3, v4
    v_bfe_u32 v5, v1, 1, 1
    s_lshl_b32 s30, s3, 1
    v_or_b32 v5, s30, v5
    v_lshlrev_b32 v3, 1, v2
    v_xor_b32 v5, v5, v3
    v_lshl_add_u32 v3, v7, 3, v2
    v_lshl_add_u32 v3, v3, 8, v4
    v_and_b32 v47, 1, v7
    v_lshlrev_b32 v47, 3, v47
    v_xor_b32 v47, v47, v5
    v_lshl_add_u32 v47, v47, 4, v3
    v_lshlrev_b32 v2, 6, v8
    v_lshl_add_u32 v2, v7, 4, v2
    v_and_or_b32 v2, v1, 8, v2
    s_lshl_b32 s30, s45, 5
    s_add_u32 s30, s30, s44
    s_lshl3_add_u32 s30, s30, s3
    s_lshl_b32 s30, s30, 9
    s_add_u32 s30, s30, 2097152
    v_add_u32 v48, s30, v2
    v_bfe_u32 v2, v1, 4, 1
    v_lshl_add_u32 v2, v2, 3, v15
    s_and_b32 s30, s2, 192
    s_cmp_eq_u32 s30, 64
    s_cselect_b32 s30, 8, 0
    v_xor_b32 v2, s30, v2
    v_mul_u32_u24 v2, 288, v2
    v_and_b32 v3, 15, v1
    v_lshl_add_u32 v2, v3, 4, v2
    v_add_u32 v54, 141824, v2
    v_lshl_add_u32 v49, v14, 3, s7
    s_lshl_b32 s30, s44, 12
    s_add_u32 s14, s30, 1048576
    v_mul_u32_u24 v2, 144, v36
    v_lshl_add_u32 v2, v15, 4, v2
    v_add_u32 v52, 65536, v2
    v_lshlrev_b32 v2, 4, v15
    v_add_u32 v53, 146688, v2
    s_lshl_b32 s30, s45, 17
    s_lshl_b32 s31, s44, 7
    s_add_u32 s30, s30, s31
    v_lshrrev_b32 v2, 1, v1
    v_lshlrev_b32 v2, 12, v2
    v_lshl_add_u32 v55, v40, 4, v2
    s_add_u32 s24, s30, 2097152
    s_lshl_b32 s30, s53, 9
    s_add_u32 s30, s30, s7
    s_buffer_load_dword s10, s[36:39], s30 offset:2048
    s_buffer_load_dword s10, s[36:39], s30 offset:2112
    s_buffer_load_dword s10, s[36:39], s30 offset:2176
    s_buffer_load_dword s10, s[36:39], s30 offset:2240
    s_buffer_load_dword s10, s[36:39], s30 offset:2304
    s_buffer_load_dword s10, s[36:39], s30 offset:2368
    s_buffer_load_dword s10, s[36:39], s30 offset:2432
    s_buffer_load_dword s10, s[36:39], s30 offset:2496
    s_and_b32 s30, s2, 31
    s_lshl3_add_u32 s30, s30, s6
    s_lshl2_add_u32 s30, s30, s53
    s_lshl_b32 s30, s30, 5
    s_buffer_load_dword s10, s[36:39], s30 offset:524288
    v_mul_u32_u24 v2, 288, v8
    v_lshl_add_u32 v2, v7, 4, v2
    v_add_u32 v62, 139520, v2
    v_and_b32 v2, 15, v1
    v_and_b32 v3, 3, v1
    v_lshlrev_b32 v3, 10, v3
    v_bfe_u32 v4, v1, 2, 2
    v_lshl_add_u32 v3, v4, 8, v3
    v_add_u32 v3, s13, v3
    v_xor_b32 v2, v2, v7
    v_xor_b32 v4, 0, v2
    v_lshl_add_u32 v56, v4, 4, v3
    v_xor_b32 v4, 4, v2
    v_lshl_add_u32 v57, v4, 4, v3
    v_xor_b32 v4, 8, v2
    v_lshl_add_u32 v58, v4, 4, v3
    v_xor_b32 v4, 12, v2
    v_lshl_add_u32 v59, v4, 4, v3
    v_lshlrev_b32 v2, 7, v7
    v_lshl_add_u32 v2, v8, 4, v2
    v_bfe_u32 v3, v1, 3, 1
    v_lshl_add_u32 v2, v3, 10, v2
    s_lshl_b32 s30, s53, 11
    s_add_u32 s30, s30, 146816
    v_add_u32 v60, s30, v2
    s_lshl_b32 s30, s53, 3
    s_add_u32 s30, s30, 146432
    v_lshl_add_u32 v61, v8, 5, s30
    v_mov_b32 v64, 0
    v_mov_b32 v80, 0
    v_mov_b32 v65, 0
    v_mov_b32 v81, 0
    v_mov_b32 v66, 0
    v_mov_b32 v82, 0
    v_mov_b32 v67, 0
    v_mov_b32 v83, 0
    v_mov_b32 v68, 0
    v_mov_b32 v84, 0
    v_mov_b32 v69, 0
    v_mov_b32 v85, 0
    v_mov_b32 v70, 0
    v_mov_b32 v86, 0
    v_mov_b32 v71, 0
    v_mov_b32 v87, 0
    v_mov_b32 v72, 0
    v_mov_b32 v88, 0
    v_mov_b32 v73, 0
    v_mov_b32 v89, 0
    v_mov_b32 v74, 0
    v_mov_b32 v90, 0
    v_mov_b32 v75, 0
    v_mov_b32 v91, 0
    v_mov_b32 v76, 0
    v_mov_b32 v92, 0
    v_mov_b32 v77, 0
    v_mov_b32 v93, 0
    v_mov_b32 v78, 0
    v_mov_b32 v94, 0
    v_mov_b32 v79, 0
    v_mov_b32 v95, 0
    s_cmp_eq_u32 s3, 7
    s_cbranch_scc1 L_pad_l1
L_ret_l1:
    s_cmp_eq_u32 s3, 6
    s_cbranch_scc1 L_pad_l2
L_ret_l2:
    s_branch L_pb_c0
    .p2align 12
L_pb_c0:
    s_waitcnt lgkmcnt(0)
    v_and_b32 v2, 1, v7
    v_lshlrev_b32 v2, 4, v2
    v_lshrrev_b32 v38, v2, s16
    v_lshrrev_b32 v39, v2, s20
    s_mov_b32 exec_lo, 0
    v_lshrrev_b32 v38, v2, s17
    v_lshrrev_b32 v39, v2, s21
    s_mov_b32 exec_lo, 0xaaaaaaaa
    s_mov_b32 exec_hi, 0
    v_lshrrev_b32 v38, v2, s18
    v_lshrrev_b32 v39, v2, s22
    s_lshl_b64 exec, exec, 32
    v_lshrrev_b32 v38, v2, s19
    v_lshrrev_b32 v39, v2, s23
    s_mov_b64 exec, -1
    s_waitcnt lgkmcnt(0)
    s_barrier
    buffer_load_dwordx4 v[96:99], v41, s[36:39], s11 offen sc1
    s_lshl2_add_u32 s31, s53, 155008
    v_mov_b32 v4, s31
    s_mov_b32 s49, 0
L_g_chk:
    s_waitcnt vmcnt(0)
    v_xor_b32 v100, s40, v96
    v_xor_b32 v101, s41, v97
    v_xor_b32 v102, s42, v98
    v_xor_b32 v103, s43, v99
    v_or3_b32 v2, v100, v101, v102
    v_or_b32 v2, v2, v103
    v_and_b32 v2, v9, v2
    v_cmp_ne_u32 vcc, 0, v2
    s_cbranch_vccz L_g_ok
    s_add_u32 s49, s49, 1
    s_cmp_gt_u32 s49, 100000
    s_cbranch_scc1 L_g_ok
    v_or3_b32 v2, v100, v101, v102
    v_or_b32 v2, v2, v103
    v_and_b32 v2, v9, v2
    v_cmp_ne_u32 vcc, 0, v2
    s_cbranch_vccz L_g_s0
    s_mov_b64 exec, vcc
    buffer_load_dwordx4 v[96:99], v41, s[36:39], s11 offen sc1
    s_mov_b64 exec, -1
L_g_s0:
    s_branch L_g_chk
L_g_ok:
    v_and_b32 v3, 0x100, v96
    v_cmp_ne_u32 vcc, 0, v3
    v_perm_b32 v100, v97, v96, s9
    v_perm_b32 v101, v99, v98, s9
    s_cmp_eq_u64 vcc, 0
    s_cselect_b32 s30, 0, 268435456
    ds_write_b64 v43, v[100:101]
    v_mov_b32 v3, s30
    ds_write_b32 v4, v3
    s_and_b32 s15, s2, 31
    s_lshl_b32 s15, s15, 10
    s_add_u32 s15, s15, 524288
    s_waitcnt lgkmcnt(0)
    s_barrier
    s_sub_u32 s30, s2, 128
    s_cmp_ge_u32 s30, 112
    s_cbranch_scc1 L_noh0
    buffer_load_dwordx4 v[176:179], v42, s[36:39], s12 offen sc1
L_noh0:
    s_mov_b64 exec, s[34:35]
    ds_read_b128 v[64:67], v62 offset:0
    ds_read_b128 v[68:71], v62 offset:64
    ds_read_b128 v[72:75], v62 offset:128
    ds_read_b128 v[76:79], v62 offset:192
    s_not_b64 exec, exec
    ds_read_b128 v[80:83], v62 offset:0
    ds_read_b128 v[84:87], v62 offset:64
    ds_read_b128 v[88:91], v62 offset:128
    ds_read_b128 v[92:95], v62 offset:192
    s_mov_b64 exec, -1
    v_mov_b32 v2, 155008
    ds_read_b128 v[180:183], v2
    ds_read_b128 v[96:99], v56 offset:0
    ds_read_b128 v[100:103], v57 offset:0
    ds_read_b128 v[104:107], v58 offset:0
    ds_read_b128 v[108:111], v59 offset:0
    ds_read_b128 v[112:115], v56 offset:4096
    ds_read_b128 v[116:119], v57 offset:4096
    ds_read_b128 v[120:123], v58 offset:4096
    ds_read_b128 v[124:127], v59 offset:4096
    s_waitcnt lgkmcnt(7)
    ds_read_b128 v[128:131], v56 offset:8192
    ds_read_b128 v[132:135], v57 offset:8192
    ds_read_b128 v[136:139], v58 offset:8192
    ds_read_b128 v[140:143], v59 offset:8192
    ds_read_b128 v[144:147], v56 offset:12288
    ds_read_b128 v[148:151], v57 offset:12288
    ds_read_b128 v[152:155], v58 offset:12288
    ds_read_b128 v[156:159], v59 offset:12288
    s_waitcnt lgkmcnt(8)
    v_mfma_f32_16x16x32_bf16 v[160:163], v[96:99], v[64:67], 0
    v_mfma_f32_16x16x32_bf16 v[164:167], v[112:115], v[64:67], 0
    v_mfma_f32_16x16x32_bf16 v[160:163], v[100:103], v[68:71], v[160:163]
    v_mfma_f32_16x16x32_bf16 v[164:167], v[116:119], v[68:71], v[164:167]
    v_mfma_f32_16x16x32_bf16 v[160:163], v[104:107], v[72:75], v[160:163]
    v_mfma_f32_16x16x32_bf16 v[164:167], v[120:123], v[72:75], v[164:167]
    v_mfma_f32_16x16x32_bf16 v[160:163], v[108:111], v[76:79], v[160:163]
    v_mfma_f32_16x16x32_bf16 v[164:167], v[124:127], v[76:79], v[164:167]
    s_nop 7
    ds_read_b128 v[96:99], v56 offset:16384
    ds_read_b128 v[100:103], v57 offset:16384
    ds_read_b128 v[104:107], v58 offset:16384
    ds_read_b128 v[108:111], v59 offset:16384
    ds_read_b128 v[112:115], v56 offset:20480
    ds_read_b128 v[116:119], v57 offset:20480
    ds_read_b128 v[120:123], v58 offset:20480
    ds_read_b128 v[124:127], v59 offset:20480
    s_waitcnt lgkmcnt(8)
    v_mfma_f32_16x16x32_bf16 v[168:171], v[128:131], v[64:67], 0
    v_mfma_f32_16x16x32_bf16 v[172:175], v[144:147], v[64:67], 0
    v_mfma_f32_16x16x32_bf16 v[168:171], v[132:135], v[68:71], v[168:171]
    v_mfma_f32_16x16x32_bf16 v[172:175], v[148:151], v[68:71], v[172:175]
    v_mfma_f32_16x16x32_bf16 v[168:171], v[136:139], v[72:75], v[168:171]
    v_mfma_f32_16x16x32_bf16 v[172:175], v[152:155], v[72:75], v[172:175]
    v_mfma_f32_16x16x32_bf16 v[168:171], v[140:143], v[76:79], v[168:171]
    v_mfma_f32_16x16x32_bf16 v[172:175], v[156:159], v[76:79], v[172:175]
    s_nop 7
    ds_read_b128 v[128:131], v56 offset:24576
    ds_read_b128 v[132:135], v57 offset:24576
    ds_read_b128 v[136:139], v58 offset:24576
    ds_read_b128 v[140:143], v59 offset:24576
    ds_read_b128 v[144:147], v56 offset:28672
    ds_read_b128 v[148:151], v57 offset:28672
    ds_read_b128 v[152:155], v58 offset:28672
    ds_read_b128 v[156:159], v59 offset:28672
    s_waitcnt lgkmcnt(8)
    v_mfma_f32_16x16x32_bf16 v[160:163], v[96:99], v[80:83], v[160:163]
    v_mfma_f32_16x16x32_bf16 v[164:167], v[112:115], v[80:83], v[164:167]
    v_mfma_f32_16x16x32_bf16 v[160:163], v[100:103], v[84:87], v[160:163]
    v_mfma_f32_16x16x32_bf16 v[164:167], v[116:119], v[84:87], v[164:167]
    v_mfma_f32_16x16x32_bf16 v[160:163], v[104:107], v[88:91], v[160:163]
    v_mfma_f32_16x16x32_bf16 v[164:167], v[120:123], v[88:91], v[164:167]
    v_mfma_f32_16x16x32_bf16 v[160:163], v[108:111], v[92:95], v[160:163]
    v_mfma_f32_16x16x32_bf16 v[164:167], v[124:127], v[92:95], v[164:167]
    s_waitcnt lgkmcnt(0)
    v_mfma_f32_16x16x32_bf16 v[168:171], v[128:131], v[80:83], v[168:171]
    v_mfma_f32_16x16x32_bf16 v[172:175], v[144:147], v[80:83], v[172:175]
    v_mfma_f32_16x16x32_bf16 v[168:171], v[132:135], v[84:87], v[168:171]
    v_mfma_f32_16x16x32_bf16 v[172:175], v[148:151], v[84:87], v[172:175]
    v_mfma_f32_16x16x32_bf16 v[168:171], v[136:139], v[88:91], v[168:171]
    v_mfma_f32_16x16x32_bf16 v[172:175], v[152:155], v[88:91], v[172:175]
    v_mfma_f32_16x16x32_bf16 v[168:171], v[140:143], v[92:95], v[168:171]
    v_mfma_f32_16x16x32_bf16 v[172:175], v[156:159], v[92:95], v[172:175]
    v_or3_b32 v2, v180, v181, v182
    v_or_b32 v2, v2, v183
    s_nop 0
    v_readfirstlane_b32 s51, v2
    s_xor_b32 s52, s51, 268435456
    v_cvt_pk_bf16_f32 v2, v160, v161
    v_and_b32 v161, 0xffff0000, v2
    v_lshlrev_b32 v160, 16, v2
    v_mul_f32 v160, 0x3db504f3, v160
    v_mul_f32 v161, 0x3db504f3, v161
    v_cvt_pk_bf16_f32 v2, v160, v161
    v_and_b32 v161, 0xffff0000, v2
    v_lshlrev_b32 v160, 16, v2
    v_cvt_pk_bf16_f32 v2, v162, v163
    v_and_b32 v163, 0xffff0000, v2
    v_lshlrev_b32 v162, 16, v2
    v_mul_f32 v162, 0x3db504f3, v162
    v_mul_f32 v163, 0x3db504f3, v163
    v_cvt_pk_bf16_f32 v2, v162, v163
    v_and_b32 v163, 0xffff0000, v2
    v_lshlrev_b32 v162, 16, v2
    v_cvt_pk_bf16_f32 v2, v164, v165
    v_and_b32 v165, 0xffff0000, v2
    v_lshlrev_b32 v164, 16, v2
    v_mul_f32 v164, 0x3db504f3, v164
    v_mul_f32 v165, 0x3db504f3, v165
    v_cvt_pk_bf16_f32 v2, v164, v165
    v_and_b32 v165, 0xffff0000, v2
    v_lshlrev_b32 v164, 16, v2
    v_cvt_pk_bf16_f32 v2, v166, v167
    v_and_b32 v167, 0xffff0000, v2
    v_lshlrev_b32 v166, 16, v2
    v_mul_f32 v166, 0x3db504f3, v166
    v_mul_f32 v167, 0x3db504f3, v167
    v_cvt_pk_bf16_f32 v2, v166, v167
    v_and_b32 v167, 0xffff0000, v2
    v_lshlrev_b32 v166, 16, v2
    v_cvt_pk_bf16_f32 v2, v168, v169
    v_and_b32 v169, 0xffff0000, v2
    v_lshlrev_b32 v168, 16, v2
    v_mul_f32 v168, 0x3db504f3, v168
    v_mul_f32 v169, 0x3db504f3, v169
    v_cvt_pk_bf16_f32 v2, v168, v169
    v_and_b32 v169, 0xffff0000, v2
    v_lshlrev_b32 v168, 16, v2
    v_cvt_pk_bf16_f32 v2, v170, v171
    v_and_b32 v171, 0xffff0000, v2
    v_lshlrev_b32 v170, 16, v2
    v_mul_f32 v170, 0x3db504f3, v170
    v_mul_f32 v171, 0x3db504f3, v171
    v_cvt_pk_bf16_f32 v2, v170, v171
    v_and_b32 v171, 0xffff0000, v2
    v_lshlrev_b32 v170, 16, v2
    v_cvt_pk_bf16_f32 v2, v172, v173
    v_and_b32 v173, 0xffff0000, v2
    v_lshlrev_b32 v172, 16, v2
    v_mul_f32 v172, 0x3db504f3, v172
    v_mul_f32 v173, 0x3db504f3, v173
    v_cvt_pk_bf16_f32 v2, v172, v173
    v_and_b32 v173, 0xffff0000, v2
    v_lshlrev_b32 v172, 16, v2
    v_cvt_pk_bf16_f32 v2, v174, v175
    v_and_b32 v175, 0xffff0000, v2
    v_lshlrev_b32 v174, 16, v2
    v_mul_f32 v174, 0x3db504f3, v174
    v_mul_f32 v175, 0x3db504f3, v175
    v_cvt_pk_bf16_f32 v2, v174, v175
    v_and_b32 v175, 0xffff0000, v2
    v_lshlrev_b32 v174, 16, v2
    v_max3_f32 v184, v160, v161, v162
    v_max3_f32 v184, v184, v163, v164
    v_max3_f32 v184, v184, v165, v166
    v_max3_f32 v184, v184, v167, v168
    v_max3_f32 v184, v184, v169, v170
    v_max3_f32 v184, v184, v171, v172
    v_max3_f32 v184, v184, v173, v174
    v_max_f32 v184, v184, v175
    s_nop 1
    v_max_f32_dpp v184, v184, v184 row_ror:8 row_mask:0xf bank_mask:0xf
    v_mov_b32 v2, v184
    s_nop 1
    v_permlane16_swap_b32 v184, v2
    v_max_f32 v184, v184, v2
    v_mov_b32 v2, v184
    s_nop 1
    v_permlane32_swap_b32 v184, v2
    v_max_f32 v184, v184, v2
    s_mov_b32 s16, 0x3fb8aa3b
    v_sub_f32 v160, v160, v184
    v_sub_f32 v161, v161, v184
    v_sub_f32 v162, v162, v184
    v_sub_f32 v163, v163, v184
    v_sub_f32 v164, v164, v184
    v_sub_f32 v165, v165, v184
    v_sub_f32 v166, v166, v184
    v_sub_f32 v167, v167, v184
    v_sub_f32 v168, v168, v184
    v_sub_f32 v169, v169, v184
    v_sub_f32 v170, v170, v184
    v_sub_f32 v171, v171, v184
    v_sub_f32 v172, v172, v184
    v_sub_f32 v173, v173, v184
    v_sub_f32 v174, v174, v184
    v_sub_f32 v175, v175, v184
    v_mul_f32 v160, s16, v160
    v_mul_f32 v161, s16, v161
    v_mul_f32 v162, s16, v162
    v_mul_f32 v163, s16, v163
    v_mul_f32 v164, s16, v164
    v_mul_f32 v165, s16, v165
    v_mul_f32 v166, s16, v166
    v_mul_f32 v167, s16, v167
    v_mul_f32 v168, s16, v168
    v_mul_f32 v169, s16, v169
    v_mul_f32 v170, s16, v170
    v_mul_f32 v171, s16, v171
    v_mul_f32 v172, s16, v172
    v_mul_f32 v173, s16, v173
    v_mul_f32 v174, s16, v174
    v_mul_f32 v175, s16, v175
    v_exp_f32 v160, v160
    v_exp_f32 v161, v161
    v_exp_f32 v162, v162
    v_exp_f32 v163, v163
    v_exp_f32 v164, v164
    v_exp_f32 v165, v165
    v_exp_f32 v166, v166
    v_exp_f32 v167, v167
    v_exp_f32 v168, v168
    v_exp_f32 v169, v169
    v_exp_f32 v170, v170
    v_exp_f32 v171, v171
    v_exp_f32 v172, v172
    v_exp_f32 v173, v173
    v_exp_f32 v174, v174
    v_exp_f32 v175, v175
    v_cvt_pk_bf16_f32 v96, v160, v161
    v_cvt_pk_bf16_f32 v97, v162, v163
    v_cvt_pk_bf16_f32 v98, v164, v165
    v_cvt_pk_bf16_f32 v99, v166, v167
    v_cvt_pk_bf16_f32 v100, v168, v169
    v_cvt_pk_bf16_f32 v101, v170, v171
    v_cvt_pk_bf16_f32 v102, v172, v173
    v_cvt_pk_bf16_f32 v103, v174, v175
    ds_write_b128 v60, v[96:99]
    ds_write_b128 v60, v[100:103] offset:512
    v_pk_add_f32 v[160:161], v[160:161], v[168:169]
    v_pk_add_f32 v[162:163], v[162:163], v[170:171]
    v_pk_add_f32 v[164:165], v[164:165], v[172:173]
    v_pk_add_f32 v[166:167], v[166:167], v[174:175]
    v_pk_add_f32 v[160:161], v[160:161], v[164:165]
    v_pk_add_f32 v[162:163], v[162:163], v[166:167]
    v_pk_add_f32 v[160:161], v[160:161], v[162:163]
    v_add_f32 v185, v160, v161
    s_nop 1
    v_add_f32_dpp v185, v185, v185 row_ror:8 row_mask:0xf bank_mask:0xf
    v_mov_b32 v2, v185
    s_nop 1
    v_permlane16_swap_b32 v185, v2
    v_add_f32 v185, v185, v2
    v_mov_b32 v2, v185
    s_nop 1
    v_permlane32_swap_b32 v185, v2
    v_add_f32 v185, v185, v2
    s_mov_b64 exec, 0xff
    ds_write_b64 v61, v[184:185]
    s_mov_b64 exec, -1
    s_waitcnt lgkmcnt(0)
    s_barrier
    s_cmp_lg_u32 s53, 3
    s_cbranch_scc1 L_noml
    v_lshlrev_b32 v2, 5, v8
    v_add_u32 v2, 146432, v2
    ds_read_b128 v[96:99], v2
    ds_read_b128 v[100:103], v2 offset:16
    s_lshl_b32 s30, s6, 7
    s_add_u32 s30, s30, s15
    v_add_u32 v3, s30, v6
    v_add_u32 v5, 146688, v6
    v_mov_b32 v110, 0
    v_mov_b32 v111, 0
    s_waitcnt lgkmcnt(0)
    v_max3_f32 v120, v96, v98, v100
    v_max_f32 v120, v120, v102
    v_sub_f32 v104, v96, v120
    v_sub_f32 v105, v98, v120
    v_sub_f32 v106, v100, v120
    v_sub_f32 v107, v102, v120
    v_mul_f32 v104, s16, v104
    v_mul_f32 v105, s16, v105
    v_mul_f32 v106, s16, v106
    v_mul_f32 v107, s16, v107
    v_exp_f32 v104, v104
    v_exp_f32 v105, v105
    v_exp_f32 v106, v106
    v_exp_f32 v107, v107
    v_mov_b32 v108, v120
    v_mul_f32 v109, v104, v97
    v_fmac_f32 v109, v105, v99
    v_fmac_f32 v109, v106, v101
    v_fmac_f32 v109, v107, v103
    v_bfi_b32 v108, v9, s40, v108
    v_bfi_b32 v109, v9, s41, v109
    v_bfi_b32 v110, v9, s42, v110
    v_bfi_b32 v111, v9, s43, v111
    s_mov_b64 exec, 0xff
    buffer_store_dwordx4 v[108:111], v3, s[36:39], s51 offen
    buffer_store_dwordx4 v[108:111], v3, s[36:39], s52 offen sc1
    s_mov_b64 exec, -1
    buffer_load_dwordx4 v[112:115], v6, s[36:39], s15 offen sc1
    s_mov_b32 s49, 0
L_m_chk:
    s_waitcnt vmcnt(0)
    v_xor_b32 v116, s40, v112
    v_xor_b32 v117, s41, v113
    v_xor_b32 v118, s42, v114
    v_xor_b32 v119, s43, v115
    v_or3_b32 v2, v116, v117, v118
    v_or_b32 v2, v2, v119
    v_and_b32 v2, v9, v2
    v_cmp_ne_u32 vcc, 0, v2
    s_cbranch_vccz L_m_ok
    s_add_u32 s49, s49, 1
    s_cmp_gt_u32 s49, 100000
    s_cbranch_scc1 L_m_ok
    v_or3_b32 v2, v116, v117, v118
    v_or_b32 v2, v2, v119
    v_and_b32 v2, v9, v2
    v_cmp_ne_u32 vcc, 0, v2
    s_cbranch_vccz L_m_s0
    s_mov_b64 exec, vcc
    buffer_load_dwordx4 v[112:115], v6, s[36:39], s15 offen sc1
    s_mov_b64 exec, -1
L_m_s0:
    s_branch L_m_chk
L_m_ok:
    v_mov_b32 v3, v116
    s_nop 1
    v_max_f32_dpp v3, v3, v3 row_ror:8 row_mask:0xf bank_mask:0xf
    v_mov_b32 v2, v3
    s_nop 1
    v_permlane16_swap_b32 v3, v2
    v_max_f32 v3, v3, v2
    v_mov_b32 v2, v3
    s_nop 1
    v_permlane32_swap_b32 v3, v2
    v_max_f32 v3, v3, v2
    v_sub_f32 v4, v116, v3
    v_sub_f32 v3, v120, v3
    v_mul_f32 v4, s16, v4
    v_mul_f32 v3, s16, v3
    v_exp_f32 v4, v4
    v_exp_f32 v3, v3
    v_mul_f32 v4, v4, v117
    s_nop 1
    v_add_f32_dpp v4, v4, v4 row_ror:8 row_mask:0xf bank_mask:0xf
    v_mov_b32 v2, v4
    s_nop 1
    v_permlane16_swap_b32 v4, v2
    v_add_f32 v4, v4, v2
    v_mov_b32 v2, v4
    s_nop 1
    v_permlane32_swap_b32 v4, v2
    v_add_f32 v4, v4, v2
    v_rcp_f32 v4, v4
    s_nop 0
    v_mul_f32 v3, v3, v4
    v_mul_f32 v104, v104, v3
    v_mul_f32 v105, v105, v3
    v_mul_f32 v106, v106, v3
    v_mul_f32 v107, v107, v3
    s_mov_b64 exec, 0xff
    ds_write_b128 v5, v[104:107]
    s_mov_b64 exec, -1
L_noml:
    s_branch L_pb_c1
    .p2align 12
L_pb_c1:
    s_sub_u32 s30, s2, 128
    s_cmp_ge_u32 s30, 112
    s_cbranch_scc1 L_noh1
    s_mov_b32 s49, 0
L_h_chk:
    s_waitcnt vmcnt(0)
    v_max3_u32 v2, v176, v177, v178
    v_max_u32 v2, v2, v179
    v_cmp_eq_u32 vcc, -1, v2
    s_cbranch_vccz L_h_ok
    s_add_u32 s49, s49, 1
    s_cmp_gt_u32 s49, 100000
    s_cbranch_scc1 L_h_ok
    s_mov_b64 exec, vcc
    buffer_load_dwordx4 v[176:179], v42, s[36:39], s12 offen sc1
    s_branch L_h_chk
L_h_ok:
    s_mov_b64 exec, -1
    ds_write_b64 v44, v[176:177]
    ds_write_b64 v45, v[178:179]
L_noh1:
    v_lshlrev_b32 v38, 16, v38
    v_lshlrev_b32 v39, 16, v39
    v_add_f32 v38, v38, v39
    s_xor_b32 s33, s33, 0x41414141
    s_bfe_u32 s40, s33, 0x10000
    s_bfe_u32 s41, s33, 0x10008
    s_bfe_u32 s42, s33, 0x10010
    s_bfe_u32 s43, s33, 0x10018
    v_mov_b32 v50, s40
    v_mov_b32 v51, s41
    s_mov_b32 exec_lo, 0xaaaaaaaa
    s_mov_b32 exec_hi, 0xaaaaaaaa
    v_mov_b32 v50, s42
    v_mov_b32 v51, s43
    s_mov_b64 exec, -1
    s_waitcnt lgkmcnt(0)
    s_barrier
    ds_read_b128 v[72:75], v53
    ds_read_b128 v[56:59], v52 offset:0
    ds_read_b128 v[60:63], v52 offset:4608
    ds_read_b128 v[64:67], v52 offset:9216
    ds_read_b128 v[68:71], v52 offset:13824
    s_waitcnt lgkmcnt(3)
    v_pk_mul_f32 v[56:57], v[56:57], v[72:73] op_sel_hi:[1,0]
    v_pk_mul_f32 v[58:59], v[58:59], v[72:73] op_sel_hi:[1,0]
    s_waitcnt lgkmcnt(2)
    v_pk_fma_f32 v[56:57], v[60:61], v[72:73], v[56:57] op_sel:[0,1,0] op_sel_hi:[1,1,1]
    v_pk_fma_f32 v[58:59], v[62:63], v[72:73], v[58:59] op_sel:[0,1,0] op_sel_hi:[1,1,1]
    s_waitcnt lgkmcnt(1)
    v_pk_fma_f32 v[56:57], v[64:65], v[74:75], v[56:57] op_sel:[0,0,0] op_sel_hi:[1,0,1]
    v_pk_fma_f32 v[58:59], v[66:67], v[74:75], v[58:59] op_sel:[0,0,0] op_sel_hi:[1,0,1]
    s_waitcnt lgkmcnt(0)
    v_pk_fma_f32 v[56:57], v[68:69], v[74:75], v[56:57] op_sel:[0,1,0] op_sel_hi:[1,1,1]
    v_pk_fma_f32 v[58:59], v[70:71], v[74:75], v[58:59] op_sel:[0,1,0] op_sel_hi:[1,1,1]
    v_cvt_pk_bf16_f32 v56, v56, v57
    v_cvt_pk_bf16_f32 v57, v58, v59
    v_bfi_b32 v56, 1, v50, v56
    v_bfi_b32 v57, 1, v51, v57
    buffer_store_dwordx2 v[56:57], v49, s[36:39], s51 offen
    s_cmp_eq_u32 s51, 0
    s_cbranch_scc1 L_pubo
    buffer_store_dwordx2 v[56:57], v49, s[36:39], s52 offen sc1
L_pubo:
    s_cmp_ge_u32 s2, 240
    s_cbranch_scc1 L_red
    s_barrier
    s_mov_b32 s17, s33
    s_lshl_b32 s30, s6, 7
    s_add_u32 s15, s15, s30
    s_xor_b32 s33, s33, 0xc1c1c1c1
    s_bfe_u32 s40, s33, 0x80000
    s_bfe_u32 s41, s33, 0x80008
    s_bfe_u32 s42, s33, 0x80010
    s_bfe_u32 s43, s33, 0x80018
    v_mov_b32 v50, s42
    v_mov_b32 v51, s43
    s_mov_b64 exec, s[34:35]
    v_mov_b32 v50, s40
    v_mov_b32 v51, s41
    s_mov_b64 exec, -1
    v_mov_b32 v196, s40
    v_mov_b32 v197, s41
    v_mov_b32 v198, s42
    v_mov_b32 v199, s43
    s_cmp_lt_u32 s2, 128
    s_cbranch_scc1 L_ac
    ds_read_b128 v[172:175], v46 offset:0
    ds_read_b128 v[176:179], v46 offset:64
    ds_read_b128 v[180:183], v46 offset:128
    ds_read_b128 v[184:187], v46 offset:192
L_ac:
    v_mov_b32 v4, s17
    s_cmp_lg_u32 s53, 3
    s_barrier
    s_cbranch_scc1 L_g2s
    s_mov_b64 exec, 1
    buffer_load_dword v4, off, s[36:39], s15 sc1
    s_mov_b64 exec, -1
L_g2s:
    s_cmp_lt_u32 s2, 128
    ds_read_b64_tr_b16 v[140:141], v47 offset:0
    ds_read_b64_tr_b16 v[142:143], v47 offset:1024
    ds_read_b64_tr_b16 v[144:145], v47 offset:8192
    ds_read_b64_tr_b16 v[146:147], v47 offset:9216
    ds_read_b64_tr_b16 v[148:149], v47 offset:16384
    ds_read_b64_tr_b16 v[150:151], v47 offset:17408
    s_cbranch_scc1 L_yc
    s_waitcnt lgkmcnt(0)
    v_mfma_f32_16x16x32_bf16 v[188:191], v[140:143], v[172:175], 0
    v_mfma_f32_16x16x32_bf16 v[188:191], v[144:147], v[176:179], v[188:191]
    v_mfma_f32_16x16x32_bf16 v[188:191], v[148:151], v[180:183], v[188:191]
L_yc:
    s_mov_b32 s49, 0
    v_mov_b32 v3, s17
    s_cmp_eq_u32 s53, 3
    s_cselect_b64 s[18:19], 1, 0
    s_mov_b32 s49, 0
    s_cmp_lt_u32 s2, 128
    s_barrier
    s_mov_b64 exec, s[18:19]
    s_cbranch_execz L_gx
    buffer_load_dword v3, off, s[36:39], s15 sc1
L_gx:
    s_mov_b64 exec, -1
    s_cbranch_scc1 L_wo
    ds_read_b64_tr_b16 v[152:153], v47 offset:24576
    ds_read_b64_tr_b16 v[154:155], v47 offset:25600
    ds_read_b64_tr_b16 v[156:157], v47 offset:32768
    ds_read_b64_tr_b16 v[158:159], v47 offset:33792
    ds_read_b64_tr_b16 v[160:161], v47 offset:40960
    ds_read_b64_tr_b16 v[162:163], v47 offset:41984
    s_waitcnt lgkmcnt(0)
    v_mfma_f32_16x16x32_bf16 v[192:195], v[156:159], v[172:175], 0
    v_mfma_f32_16x16x32_bf16 v[192:195], v[160:163], v[176:179], v[192:195]
    v_mfma_f32_16x16x32_bf16 v[188:191], v[152:155], v[184:187], v[188:191]
    s_branch L_o_ok
L_wo:
    buffer_load_dwordx4 v[76:79], v42, s[36:39], s14 offen sc1
    ds_read_b64_tr_b16 v[152:153], v47 offset:24576
    ds_read_b64_tr_b16 v[154:155], v47 offset:25600
    ds_read_b64_tr_b16 v[156:157], v47 offset:32768
    ds_read_b64_tr_b16 v[158:159], v47 offset:33792
    ds_read_b64_tr_b16 v[160:161], v47 offset:40960
    ds_read_b64_tr_b16 v[162:163], v47 offset:41984
L_o_chk:
    s_waitcnt vmcnt(0)
    ds_write_b128 v54, v[76:79]
    v_max3_u32 v2, v76, v77, v78
    v_max_u32 v2, v2, v79
    v_cmp_eq_u32 vcc, -1, v2
    s_cbranch_vccz L_o_ok
    s_add_u32 s49, s49, 1
    s_cmp_gt_u32 s49, 100000
    s_cbranch_scc1 L_o_ok
    s_mov_b64 exec, vcc
    buffer_load_dwordx4 v[76:79], v42, s[36:39], s14 offen sc1
    s_branch L_o_chk
L_o_ok:
    s_mov_b64 exec, -1
    s_waitcnt vmcnt(1)
    v_cmp_ne_u32 vcc, s17, v4
    s_cbranch_vccz L_gy_ok
L_gy_chk:
    s_waitcnt vmcnt(0)
    v_cmp_ne_u32 vcc, s17, v3
    s_cbranch_vccz L_gy_ok
    s_add_u32 s49, s49, 1
    s_cmp_gt_u32 s49, 100000
    s_cbranch_scc1 L_gy_ok
    s_mov_b64 exec, vcc
    buffer_load_dword v3, off, s[36:39], s15 sc1
    s_branch L_gy_chk
L_gy_ok:
    s_mov_b64 exec, -1
    s_cmp_lt_u32 s2, 128
    s_waitcnt lgkmcnt(0)
    s_barrier
    s_cbranch_scc1 L_lwc
    ds_read_b64_tr_b16 v[164:165], v47 offset:49152
    ds_read_b64_tr_b16 v[166:167], v47 offset:50176
    ds_read_b64_tr_b16 v[168:169], v47 offset:57344
    ds_read_b64_tr_b16 v[170:171], v47 offset:58368
    s_branch L_lxc
L_lwc:
    ds_read_b128 v[172:175], v46 offset:0
    ds_read_b128 v[176:179], v46 offset:64
    ds_read_b128 v[180:183], v46 offset:128
    ds_read_b128 v[184:187], v46 offset:192
    ds_read_b64_tr_b16 v[164:165], v47 offset:49152
    ds_read_b64_tr_b16 v[166:167], v47 offset:50176
    ds_read_b64_tr_b16 v[168:169], v47 offset:57344
    ds_read_b64_tr_b16 v[170:171], v47 offset:58368
    s_waitcnt lgkmcnt(7)
    v_mfma_f32_16x16x32_bf16 v[188:191], v[140:143], v[172:175], 0
    v_mfma_f32_16x16x32_bf16 v[192:195], v[156:159], v[172:175], 0
    s_waitcnt lgkmcnt(6)
    v_mfma_f32_16x16x32_bf16 v[188:191], v[144:147], v[176:179], v[188:191]
    v_mfma_f32_16x16x32_bf16 v[192:195], v[160:163], v[176:179], v[192:195]
    s_waitcnt lgkmcnt(5)
    v_mfma_f32_16x16x32_bf16 v[188:191], v[148:151], v[180:183], v[188:191]
    s_waitcnt lgkmcnt(4)
    v_mfma_f32_16x16x32_bf16 v[188:191], v[152:155], v[184:187], v[188:191]
L_lxc:
    s_waitcnt lgkmcnt(2)
    v_mfma_f32_16x16x32_bf16 v[192:195], v[164:167], v[180:183], v[192:195]
    s_waitcnt lgkmcnt(0)
    v_mfma_f32_16x16x32_bf16 v[192:195], v[168:171], v[184:187], v[192:195]
    s_nop 7
    v_add_f32_dpp v188, v192, v188 row_ror:8 row_mask:0xf bank_mask:0x3
    v_add_f32_dpp v189, v193, v189 row_ror:8 row_mask:0xf bank_mask:0x3
    s_cmp_eq_u32 s51, 0
    v_add_f32_dpp v188, v190, v194 row_ror:8 row_mask:0xf bank_mask:0xc
    v_add_f32_dpp v189, v191, v195 row_ror:8 row_mask:0xf bank_mask:0xc
    v_bfi_b32 v188, v9, v50, v188
    v_bfi_b32 v189, v9, v51, v189
    buffer_store_dwordx2 v[188:189], v48, s[36:39], s51 offen
    s_cbranch_scc1 L_pubfc
    buffer_store_dwordx2 v[188:189], v48, s[36:39], s52 offen sc1
L_pubfc:
L_last:
    s_cmp_ge_u32 s53, 4
    s_cbranch_scc1 L_fin
    s_mov_b32 exec_hi, 0xfffffff
    buffer_load_dwordx4 v[196:199], v55, s[36:39], s24 offen sc1
    s_mov_b64 exec, -1
    s_mov_b32 s49, 0
L_r_chk:
    s_waitcnt vmcnt(0)
    v_xor_b32 v108, s40, v196
    v_xor_b32 v109, s41, v197
    v_xor_b32 v110, s42, v198
    v_xor_b32 v111, s43, v199
    v_or3_b32 v2, v108, v109, v110
    v_or_b32 v2, v2, v111
    v_cmp_ne_u32_sdwa vcc, v2, v10 src0_sel:BYTE_0 src1_sel:DWORD
    s_cbranch_vccz L_r_ok
    s_mov_b64 exec, vcc
    buffer_load_dwordx4 v[196:199], v55, s[36:39], s24 offen sc1
    s_add_u32 s49, s49, 1
    s_bcnt1_i32_b64 s30, vcc
    s_cmp_lt_u32 s49, 100000
    s_cselect_b32 s30, s30, 0
    s_cmp_gt_u32 s30, 64
    s_cbranch_scc1 L_r_chk
    buffer_load_dwordx4 v[76:79], v55, s[36:39], s24 offen sc1
L_r_fast:
    s_waitcnt vmcnt(1)
    v_xor_b32 v108, s40, v196
    v_xor_b32 v109, s41, v197
    v_xor_b32 v110, s42, v198
    v_xor_b32 v111, s43, v199
    v_or3_b32 v2, v108, v109, v110
    v_or_b32 v2, v2, v111
    v_cmp_ne_u32_sdwa vcc, v2, v10 src0_sel:BYTE_0 src1_sel:DWORD
    s_cbranch_vccz L_r_ok
    s_mov_b64 exec, vcc
    buffer_load_dwordx4 v[196:199], v55, s[36:39], s24 offen sc1
    s_waitcnt vmcnt(1)
    v_xor_b32 v108, s40, v76
    v_xor_b32 v109, s41, v77
    v_xor_b32 v110, s42, v78
    v_xor_b32 v111, s43, v79
    v_or3_b32 v2, v108, v109, v110
    v_or_b32 v2, v2, v111
    v_cmp_ne_u32_sdwa vcc, v2, v10 src0_sel:BYTE_0 src1_sel:DWORD
    s_cbranch_vccz L_r_ok
    s_mov_b64 exec, vcc
    buffer_load_dwordx4 v[76:79], v55, s[36:39], s24 offen sc1
    s_add_u32 s49, s49, 1
    s_cmp_lt_u32 s49, 100000
    s_cbranch_scc1 L_r_fast
L_r_ok:
    s_mov_b64 exec, -1
    v_permlane32_swap_b32 v108, v110
    v_permlane32_swap_b32 v109, v111
    v_add_f32 v108, v108, v110
    v_add_f32 v109, v109, v111
    s_nop 1
    v_permlane16_swap_b32 v108, v109
    v_add_f32 v108, v108, v109
    s_nop 1
    v_add_f32_dpp v108, v108, v108 row_ror:8 row_mask:0xf bank_mask:0xf
    s_nop 1
    v_add_f32_dpp v108, v108, v108 row_ror:4 row_mask:0xf bank_mask:0xf
    s_nop 1
    v_add_f32_dpp v108, v108, v108 row_ror:2 row_mask:0xf bank_mask:0xf
    s_mov_b32 exec_lo, 0x30003
    s_mov_b32 exec_hi, 0x30003
    v_add_f32 v108, v108, v38
    v_cvt_pk_bf16_f32 v108, v108, v108
    buffer_store_short v108, v37, s[68:71], 0 offen
    s_mov_b32 s31, 268435456
    s_cmp_eq_u32 s2, 0
    s_cselect_b32 s30, 589824, s31
    v_mov_b32 v2, s33
    s_mov_b64 exec, 1
    buffer_store_dword v2, off, s[36:39], s30
    s_mov_b64 exec, -1
L_fin:
    s_endpgm
L_redl:
    s_waitcnt vmcnt(0)
    s_xor_b32 s33, s33, 0xc1c1c1c1
    s_bfe_u32 s40, s33, 0x10000
    s_bfe_u32 s41, s33, 0x10008
    s_bfe_u32 s42, s33, 0x10010
    s_bfe_u32 s43, s33, 0x10018
L_red:
    s_and_b32 s30, s44, 1
    s_lshl3_add_u32 s30, s30, s3
    s_lshl_b32 s31, s45, 7
    s_add_u32 s31, s31, s30
    s_lshl_b32 s31, s31, 10
    s_add_u32 s31, s31, 2097152
    s_and_b32 s32, s3, 3
    s_lshl_b32 s32, s32, 9
    s_sub_u32 s31, s31, s32
    v_lshrrev_b32 v4, 5, v1
    v_mul_u32_u24 v2, 65024, v4
    v_add3_u32 v200, s31, v6, v2
    v_add_u32 v201, 16384, v200
    v_add_u32 v202, 32768, v200
    v_add_u32 v203, 49152, v200
    buffer_load_dwordx4 v[76:79], v200, s[36:39], 0 offen sc1
    buffer_load_dwordx4 v[80:83], v201, s[36:39], 0 offen sc1
    buffer_load_dwordx4 v[84:87], v202, s[36:39], 0 offen sc1
    buffer_load_dwordx4 v[88:91], v203, s[36:39], 0 offen sc1
    s_and_b32 s31, s45, 3
    s_and_b32 s32, s3, 3
    s_lshl2_add_u32 s31, s31, s32
    s_lshr_b32 s30, s30, 2
    s_lshl2_add_u32 s31, s31, s30
    s_lshr_b32 s30, s45, 2
    s_lshl1_add_u32 s31, s31, s30
    s_lshl_b32 s31, s31, 9
    s_add_u32 s31, s31, 1048576
    v_lshl_add_u32 v4, v1, 1, v4
    v_and_b32 v4, 63, v4
    v_mul_u32_u24 v5, 25, v4
    v_bfi_b32 v5, 31, v5, v4
    v_lshlrev_b32 v5, 3, v5
    s_lshr_b32 s30, s3, 2
    s_lshl1_add_u32 s30, s44, s30
    s_and_b32 s30, s30, 3
    s_lshl3_add_u32 s30, s30, s45
    s_lshl_b32 s30, s30, 10
    s_add_u32 s30, s30, 524288
    v_lshl_add_u32 v208, v1, 7, s30
    v_mov_b32 v209, s33
    s_mov_b32 s49, 0
    s_mov_b32 s32, 15
    s_mov_b32 s30, 268435456
    s_mov_b32 s47, 0x8000
L_p_0:
    s_bitcmp1_b32 s32, 0
    s_cbranch_scc0 L_p_d0
    s_waitcnt vmcnt(3)
    v_xor_b32 v92, s40, v76
    v_xor_b32 v93, s41, v77
    v_xor_b32 v94, s42, v78
    v_xor_b32 v95, s43, v79
    v_or3_b32 v2, v92, v93, v94
    v_bitop3_b32 v2, v2, v95, 1 bitop3:0xa8
    v_cmp_ne_u32 vcc, 0, v2
    s_cbranch_vccz L_p_e0
    buffer_load_dwordx4 v[76:79], v200, s[36:39], 0 offen sc1
L_p_1:
    s_bitcmp1_b32 s32, 1
    s_cbranch_scc0 L_p_d1
    s_waitcnt vmcnt(3)
    v_xor_b32 v92, s40, v80
    v_xor_b32 v93, s41, v81
    v_xor_b32 v94, s42, v82
    v_xor_b32 v95, s43, v83
    v_or3_b32 v2, v92, v93, v94
    v_bitop3_b32 v2, v2, v95, 1 bitop3:0xa8
    v_cmp_ne_u32 vcc, 0, v2
    s_cbranch_vccz L_p_e1
    buffer_load_dwordx4 v[80:83], v201, s[36:39], 0 offen sc1
L_p_2:
    s_bitcmp1_b32 s32, 2
    s_cbranch_scc0 L_p_d2
    s_waitcnt vmcnt(3)
    v_xor_b32 v92, s40, v84
    v_xor_b32 v93, s41, v85
    v_xor_b32 v94, s42, v86
    v_xor_b32 v95, s43, v87
    v_or3_b32 v2, v92, v93, v94
    v_bitop3_b32 v2, v2, v95, 1 bitop3:0xa8
    v_cmp_ne_u32 vcc, 0, v2
    s_cbranch_vccz L_p_e2
    buffer_load_dwordx4 v[84:87], v202, s[36:39], 0 offen sc1
L_p_3:
    s_bitcmp1_b32 s32, 3
    s_cbranch_scc0 L_p_d3
    s_waitcnt vmcnt(3)
    v_xor_b32 v92, s40, v88
    v_xor_b32 v93, s41, v89
    v_xor_b32 v94, s42, v90
    v_xor_b32 v95, s43, v91
    v_or3_b32 v2, v92, v93, v94
    v_bitop3_b32 v2, v2, v95, 1 bitop3:0xa8
    v_cmp_ne_u32 vcc, 0, v2
    s_cbranch_vccz L_p_e3
    buffer_load_dwordx4 v[88:91], v203, s[36:39], 0 offen sc1
L_p_4:
    s_add_u32 s49, s49, 1
    s_cmp_lt_u32 s49, 100000
    s_cbranch_scc1 L_p_0
    s_branch L_p_x
L_p_e0:
    s_and_b32 s32, s32, 14
    v_lshl_or_b32 v108, v92, 16, s47
    v_and_b32 v109, 0xffff0000, v92
    v_lshl_or_b32 v110, v93, 16, s47
    v_and_b32 v111, 0xffff0000, v93
    v_lshl_or_b32 v112, v94, 16, s47
    v_and_b32 v113, 0xffff0000, v94
    v_lshl_or_b32 v114, v95, 16, s47
    v_and_b32 v115, 0xffff0000, v95
    s_cbranch_scc0 L_p_x
L_p_d0:
    buffer_load_dword v3, off, s[36:39], s30
    s_branch L_p_1
L_p_e1:
    s_and_b32 s32, s32, 13
    v_lshl_or_b32 v116, v92, 16, s47
    v_and_b32 v117, 0xffff0000, v92
    v_lshl_or_b32 v118, v93, 16, s47
    v_and_b32 v119, 0xffff0000, v93
    v_lshl_or_b32 v120, v94, 16, s47
    v_and_b32 v121, 0xffff0000, v94
    v_lshl_or_b32 v122, v95, 16, s47
    v_and_b32 v123, 0xffff0000, v95
    s_cbranch_scc0 L_p_x
L_p_d1:
    buffer_load_dword v3, off, s[36:39], s30
    s_branch L_p_2
L_p_e2:
    s_and_b32 s32, s32, 11
    v_lshl_or_b32 v124, v92, 16, s47
    v_and_b32 v125, 0xffff0000, v92
    v_lshl_or_b32 v126, v93, 16, s47
    v_and_b32 v127, 0xffff0000, v93
    v_lshl_or_b32 v128, v94, 16, s47
    v_and_b32 v129, 0xffff0000, v94
    v_lshl_or_b32 v130, v95, 16, s47
    v_and_b32 v131, 0xffff0000, v95
    s_cbranch_scc0 L_p_x
L_p_d2:
    buffer_load_dword v3, off, s[36:39], s30
    s_branch L_p_3
L_p_e3:
    s_and_b32 s32, s32, 7
    v_lshl_or_b32 v132, v92, 16, s47
    v_and_b32 v133, 0xffff0000, v92
    v_lshl_or_b32 v134, v93, 16, s47
    v_and_b32 v135, 0xffff0000, v93
    v_lshl_or_b32 v136, v94, 16, s47
    v_and_b32 v137, 0xffff0000, v94
    v_lshl_or_b32 v138, v95, 16, s47
    v_and_b32 v139, 0xffff0000, v95
    s_cbranch_scc0 L_p_x
L_p_d3:
    buffer_load_dword v3, off, s[36:39], s30
    s_branch L_p_4
L_p_x:
    v_pk_add_f32 v[108:109], v[108:109], v[124:125]
    v_pk_add_f32 v[110:111], v[110:111], v[126:127]
    v_pk_add_f32 v[112:113], v[112:113], v[128:129]
    v_pk_add_f32 v[114:115], v[114:115], v[130:131]
    v_pk_add_f32 v[116:117], v[116:117], v[132:133]
    v_pk_add_f32 v[118:119], v[118:119], v[134:135]
    v_pk_add_f32 v[120:121], v[120:121], v[136:137]
    v_pk_add_f32 v[122:123], v[122:123], v[138:139]
    v_pk_add_f32 v[108:109], v[108:109], v[116:117]
    v_pk_add_f32 v[110:111], v[110:111], v[118:119]
    v_pk_add_f32 v[112:113], v[112:113], v[120:121]
    v_pk_add_f32 v[114:115], v[114:115], v[122:123]
    s_nop 0
    v_permlane32_swap_b32 v108, v112
    v_permlane32_swap_b32 v109, v113
    v_permlane32_swap_b32 v110, v114
    v_permlane32_swap_b32 v111, v115
    v_pk_add_f32 v[108:109], v[108:109], v[112:113]
    v_pk_add_f32 v[110:111], v[110:111], v[114:115]
    v_cvt_pk_bf16_f32 v112, v108, v109
    v_cvt_pk_bf16_f32 v113, v110, v111
    v_min_u32 v112, -2, v112
    v_min_u32 v113, -2, v113
    s_and_b32 s30, s3, 3
    s_barrier
    s_cbranch_scc1 L_nofl
    s_mov_b64 exec, 0xff
    buffer_store_dword v209, v208, s[36:39], s51 offen
    s_cmp_eq_u32 s51, 0
    s_cbranch_scc1 L_pubg
    buffer_store_dword v209, v208, s[36:39], s52 offen sc1
L_pubg:
    s_mov_b64 exec, -1
L_nofl:
    buffer_store_dwordx2 v[112:113], v5, s[36:39], s31 offen sc1
    s_xor_b32 s33, s33, 0xc1c1c1c1
    s_bfe_u32 s40, s33, 0x80000
    s_bfe_u32 s41, s33, 0x80008
    s_bfe_u32 s42, s33, 0x80010
    s_bfe_u32 s43, s33, 0x80018
    v_mov_b32 v196, s40
    v_mov_b32 v197, s41
    v_mov_b32 v198, s42
    v_mov_b32 v199, s43
    s_cmp_ge_u32 s3, 4
    s_cbranch_scc1 L_last
    s_branch L_finl
L_end:
    s_endpgm
.section .rodata,"a"
.p2align 6
.amdhsa_kernel parallel_sum__gqa_block_cached__dense_activation_squared_relu__decode_kernel
  .amdhsa_next_free_vgpr 248
  .amdhsa_next_free_sgpr 102
  .amdhsa_accum_offset 248
  .amdhsa_group_segment_fixed_size 0
  .amdhsa_kernarg_size 104
  .amdhsa_user_sgpr_count 2
  .amdhsa_user_sgpr_kernarg_segment_ptr 1
  .amdhsa_system_sgpr_workgroup_id_x 1
  .amdhsa_float_denorm_mode_32 3
.end_amdhsa_kernel
```
